```python
import torch

def _softmax(x, axis=-1):
    return torch.softmax(x, dim=axis)
def _gelu(x):
    return torch.nn.functional.gelu(x, approximate="tanh")
def _silu(x):
    return torch.nn.functional.silu(x)
def _sigmoid(x):
    return torch.sigmoid(x)
def _layernorm(x, axis=-1, eps=1e-5):
    m = x.mean(dim=axis, keepdim=True)
    v = x.var(dim=axis, keepdim=True, unbiased=False)
    return (x - m) / torch.sqrt(v + eps)
def _scatter_add(tgt, idx, src, axis=0):
    return tgt.clone().index_add_(axis, idx, src)
def _segment_sum(src, seg, n):
    out = torch.zeros((n,) + src.shape[1:], dtype=src.dtype)
    return out.index_add_(0, seg, src)
def _pad(x, pw):
    flat = tuple(v for pair in reversed(pw) for v in pair)
    return torch.nn.functional.pad(x, flat)

kernel_name = 'sequential_preLN__ssm_conv_s4d__mixer_token_mlp__prompt'

def setup_inputs():

    _w = (lambda a: (lambda t: t.to(torch.bfloat16) if t.is_floating_point() else t)(torch.as_tensor(a)))
    def _A_setup():
        Bsz, L, D, N = 1, 2048, 640, 128
        return {
            "u": _w((lambda *s: torch.randn(*s, dtype=torch.bfloat16) * 0.05)(Bsz, L, D)),
            "log_A_real": _w((lambda *s: torch.randn(*s, dtype=torch.bfloat16) * 6.4)(D, N) * 0.5),
            "A_imag": _w((lambda *s: torch.randn(*s, dtype=torch.bfloat16) * 0.05)(D, N) * 3.14),
            "C_real": _w((lambda *s: torch.randn(*s, dtype=torch.bfloat16) * 0.05)(D, N) / N ** 0.5),
            "C_imag": _w((lambda *s: torch.randn(*s, dtype=torch.bfloat16) * 0.05)(D, N) / N ** 0.5),
            "log_dt": _w((lambda *s: torch.randn(*s, dtype=torch.bfloat16) * 0.05)(D) * 0.5 - 4.0),
            "D_skip": _w((lambda *s: torch.randn(*s, dtype=torch.bfloat16) * 0.05)(D)),
        }
    _A_in = _A_setup()

    def _B_setup():
        B, S, D, F = 1, 2048, 640, 1728
        return {
            "x": _w((lambda *s: torch.randn(*s, dtype=torch.bfloat16) * 0.05)(B, S, D)),
            "w1": _w((lambda *s: torch.randn(*s, dtype=torch.bfloat16) * 0.4)(S, F) * (S ** -0.5)),
            "b1": _w((lambda *s: torch.randn(*s, dtype=torch.bfloat16) * 12.8)(F) * 0.02),
            "w2": _w((lambda *s: torch.randn(*s, dtype=torch.bfloat16) * 0.2)(F, S) * (F ** -0.5)),
            "b2": _w((lambda *s: torch.randn(*s, dtype=torch.bfloat16) * 3.2)(S) * 0.02),
        }
    _B_in = _B_setup()

    return {
        "A_u": _A_in["u"],
        "A_log_A_real": _A_in["log_A_real"],
        "A_A_imag": _A_in["A_imag"],
        "A_C_real": _A_in["C_real"],
        "A_C_imag": _A_in["C_imag"],
        "A_log_dt": _A_in["log_dt"],
        "A_D_skip": _A_in["D_skip"],
        "B_x": _B_in["x"],
        "B_w1": _B_in["w1"],
        "B_b1": _B_in["b1"],
        "B_w2": _B_in["w2"],
        "B_b2": _B_in["b2"],
    }

def reference(A_u, A_log_A_real, A_A_imag, A_C_real, A_C_imag, A_log_dt, A_D_skip, B_x, B_w1, B_b1, B_w2, B_b2):
    def _A_ref(u, log_A_real, A_imag, C_real, C_imag, log_dt, D_skip):
        L = u.shape[1]
        dt = torch.exp(log_dt)
        A = -torch.exp(log_A_real) + 1j * A_imag
        C = (C_real + 1j * C_imag) * dt[:, None]
        pos = (lambda x, dt: x.to(dt))(torch.arange(L), log_dt.dtype)
        P = torch.exp((A * dt[:, None])[:, :, None] * pos[None, None, :])
        K = 2.0 * torch.einsum("dn,dnl->dl", C, P).real
        L2 = 2 * L
        u_t = (lambda x, *d: x.permute(*d))(u, 0, 2, 1)
        Kf = (lambda x, *a, **k: torch.fft.rfft(x.float(), *a, **k))(K, L2)
        Uf = (lambda x, *a, **k: torch.fft.rfft(x.float(), *a, **k))(u_t, L2)
        y = (lambda x, *a, **k: torch.fft.irfft(x, *a, **k).to(torch.bfloat16))(Uf * Kf[None, :, :], L2)[:, :, :L]
        y = (lambda x, *d: x.permute(*d))(y, 0, 2, 1)
        return y + u * D_skip[None, None, :]

    def _B_ref(x, w1, b1, w2, b2):
        B, S, D = x.shape
        h = _layernorm(x, axis=-1)
        u = torch.einsum("bsd,sf->bdf", h, w1) + b1
        u = _gelu(u)
        y = torch.einsum("bdf,fs->bds", u, w2) + b2
        return (lambda x, *d: x.permute(*d))(y, 0, 2, 1)

    x = A_u
    h = x + _A_ref(_layernorm(x, axis=-1), A_log_A_real, A_A_imag, A_C_real, A_C_imag, A_log_dt, A_D_skip)
    h2 = h + _B_ref(_layernorm(h, axis=-1), B_w1, B_b1, B_w2, B_b2)
    return h2
```

```asm
; @launch kernel=k12_kernel grid=(776,1,1) block=(256,1,1) lds=40960
; @launch kernel=k3_kernel grid=(256,1,1) block=(640,1,1) lds=22528
; @launch kernel=gemm1_kernel grid=(256,1,1) block=(448,1,1) lds=92160
; @launch kernel=gemm2_kernel grid=(256,1,1) block=(448,1,1) lds=92160
.amdgcn_target "amdgcn-amd-amdhsa--gfx950"
.text
.globl k12_kernel
.p2align 8
.type k12_kernel,@function
k12_kernel:
  s_cmp_ge_u32 s2, 8
  s_cbranch_scc1 k12_kernel_main
  s_cmp_lg_u32 s2, 0
  s_cbranch_scc1 k12_kernel_svc2
  s_load_dwordx4 s[4:7], s[0:1], 104
  v_lshlrev_b32 v2, 4, v0
  v_pk_mov_b32 v[4:5], 0, 0
  v_pk_mov_b32 v[6:7], 0, 0
  s_mov_b32 s10, 20480
  s_mov_b32 s11, 0x00020000
  v_mov_b32 v3, 1
  s_waitcnt lgkmcnt(0)
  s_add_u32 s8, s6, 30408704
  s_addc_u32 s9, s7, 0
  s_mov_b32 s12, 0
  buffer_store_dwordx4 v[4:7], v2, s[8:11], s12 offen sc1
  s_mov_b32 s12, 4096
  buffer_store_dwordx4 v[4:7], v2, s[8:11], s12 offen sc1
  s_mov_b32 s12, 8192
  buffer_store_dwordx4 v[4:7], v2, s[8:11], s12 offen sc1
  s_mov_b32 s12, 12288
  buffer_store_dwordx4 v[4:7], v2, s[8:11], s12 offen sc1
  s_mov_b32 s12, 16384
  buffer_store_dwordx4 v[4:7], v2, s[8:11], s12 offen sc1
  s_waitcnt vmcnt(0)
  s_barrier
  global_store_dword v4, v3, s[4:5] sc1
k12_kernel_svc2:
  s_getpc_b64 s[20:21]
k12_kernel_pc:
  s_sub_u32 s20, s20, k12_kernel_pc-k12_kernel
  s_subb_u32 s21, s21, 0
  s_mov_b32 s22, code_pf_end-k12_kernel
  s_mov_b32 s23, 0x00020000
  v_lshlrev_b32 v2, 7, v0
  buffer_load_dword v12, v2, s[20:23], 0 offen
  s_load_dwordx2 s[24:25], s[0:1], 48
  s_load_dwordx2 s[28:29], s[0:1], 72
  s_load_dwordx2 s[32:33], s[0:1], 88
  s_mov_b32 s26, 1280
  s_mov_b32 s27, 0x00020000
  s_mov_b32 s30, 3456
  s_mov_b32 s31, 0x00020000
  s_mov_b32 s34, 4096
  s_mov_b32 s35, 0x00020000
  s_waitcnt lgkmcnt(0)
  buffer_load_dword v13, v2, s[24:27], 0 offen
  buffer_load_dword v14, v2, s[28:31], 0 offen
  buffer_load_dword v15, v2, s[32:35], 0 offen
  s_endpgm
k12_kernel_main:
  s_cmp_ge_u32 s2, 776
  s_cbranch_scc1 k12_kernel_done
  s_sub_u32 s2, s2, 8
  s_cmp_ge_u32 s2, 768
  s_cbranch_scc1 k12_kernel_ln2
  s_cmp_ge_u32 s2, 128
  s_cbranch_scc1 k12_kernel_kgen

  s_load_dwordx2 s[4:5], s[0:1], 0
  s_load_dwordx2 s[6:7], s[0:1], 112
  s_load_dwordx2 s[28:29], s[0:1], 104
  s_setprio 3
  s_lshl_b32 s16, s2, 4
  v_lshrrev_b32 v1, 4, v0
  v_and_b32 v2, 15, v0
  v_add_u32 v3, s16, v1
  v_mul_u32_u24 v3, 1280, v3
  v_lshl_add_u32 v3, v2, 4, v3
  s_waitcnt lgkmcnt(0)
  s_add_u32 s30, s6, 30408704
  s_addc_u32 s31, s7, 0
  s_mov_b32 s8, s4
  s_mov_b32 s9, s5
  s_mov_b32 s10, 2621440
  s_mov_b32 s11, 0x00020000
  buffer_load_dwordx4 v[8:11], v3, s[8:11], 0 offen offset:0
  buffer_load_dwordx4 v[12:15], v3, s[8:11], 0 offen offset:256
  buffer_load_dwordx4 v[16:19], v3, s[8:11], 0 offen offset:512
  buffer_load_dwordx4 v[20:23], v3, s[8:11], 0 offen offset:768
  buffer_load_dwordx4 v[24:27], v3, s[8:11], 0 offen offset:1024
  s_mov_b32 s12, s6
  s_mov_b32 s13, s7
  s_mov_b32 s14, 2637824
  s_mov_b32 s15, 0x00020000
  s_add_u32 s20, s6, 29360128
  s_addc_u32 s21, s7, 0
  s_mov_b32 s22, 16384
  s_mov_b32 s23, 0x00020000
  v_mul_u32_u24 v4, 1312, v1
  v_lshl_add_u32 v4, v2, 4, v4
  v_bfe_u32 v5, v0, 4, 1
  v_bfe_u32 v6, v0, 2, 2
  v_lshl_add_u32 v5, v5, 3, v6
  v_mul_u32_u24 v5, 1312, v5
  v_bfe_u32 v6, v0, 5, 1
  v_lshl_add_u32 v5, v6, 5, v5
  v_and_b32 v7, 3, v0
  v_lshl_add_u32 v5, v7, 3, v5
  v_lshrrev_b32 v7, 6, v0
  v_mul_u32_u24 v72, 320, v7
  v_add_u32 v5, v5, v72
  v_mul_u32_u24 v72, 160, v7
  v_lshl_add_u32 v72, v6, 4, v72
  v_add_u32 v72, v72, v2
  v_lshlrev_b32 v72, 5, v72
  v_and_b32 v6, 16, v0
  s_mul_i32 s17, s2, 20608
  v_add3_u32 v6, v6, v72, s17
  v_add_u32 v7, s16, v1
  v_lshlrev_b32 v7, 3, v7
  s_waitcnt vmcnt(4)
  v_lshlrev_b32 v32, 16, v8
  v_and_b32 v33, 0xffff0000, v8
  v_lshlrev_b32 v34, 16, v9
  v_and_b32 v35, 0xffff0000, v9
  v_lshlrev_b32 v36, 16, v10
  v_and_b32 v37, 0xffff0000, v10
  v_lshlrev_b32 v38, 16, v11
  v_and_b32 v39, 0xffff0000, v11
  v_pk_add_f32 v[72:73], v[32:33], v[34:35]
  v_pk_add_f32 v[74:75], v[36:37], v[38:39]
  s_waitcnt vmcnt(3)
  v_lshlrev_b32 v40, 16, v12
  v_and_b32 v41, 0xffff0000, v12
  v_lshlrev_b32 v42, 16, v13
  v_and_b32 v43, 0xffff0000, v13
  v_lshlrev_b32 v44, 16, v14
  v_and_b32 v45, 0xffff0000, v14
  v_lshlrev_b32 v46, 16, v15
  v_and_b32 v47, 0xffff0000, v15
  v_pk_add_f32 v[72:73], v[72:73], v[40:41]
  v_pk_add_f32 v[74:75], v[74:75], v[42:43]
  v_pk_add_f32 v[72:73], v[72:73], v[44:45]
  v_pk_add_f32 v[74:75], v[74:75], v[46:47]
  s_waitcnt vmcnt(2)
  v_lshlrev_b32 v48, 16, v16
  v_and_b32 v49, 0xffff0000, v16
  v_lshlrev_b32 v50, 16, v17
  v_and_b32 v51, 0xffff0000, v17
  v_lshlrev_b32 v52, 16, v18
  v_and_b32 v53, 0xffff0000, v18
  v_lshlrev_b32 v54, 16, v19
  v_and_b32 v55, 0xffff0000, v19
  v_pk_add_f32 v[72:73], v[72:73], v[48:49]
  v_pk_add_f32 v[74:75], v[74:75], v[50:51]
  v_pk_add_f32 v[72:73], v[72:73], v[52:53]
  v_pk_add_f32 v[74:75], v[74:75], v[54:55]
  s_waitcnt vmcnt(1)
  v_lshlrev_b32 v56, 16, v20
  v_and_b32 v57, 0xffff0000, v20
  v_lshlrev_b32 v58, 16, v21
  v_and_b32 v59, 0xffff0000, v21
  v_lshlrev_b32 v60, 16, v22
  v_and_b32 v61, 0xffff0000, v22
  v_lshlrev_b32 v62, 16, v23
  v_and_b32 v63, 0xffff0000, v23
  v_pk_add_f32 v[72:73], v[72:73], v[56:57]
  v_pk_add_f32 v[74:75], v[74:75], v[58:59]
  v_pk_add_f32 v[72:73], v[72:73], v[60:61]
  v_pk_add_f32 v[74:75], v[74:75], v[62:63]
  s_waitcnt vmcnt(0)
  v_lshlrev_b32 v64, 16, v24
  v_and_b32 v65, 0xffff0000, v24
  v_lshlrev_b32 v66, 16, v25
  v_and_b32 v67, 0xffff0000, v25
  v_lshlrev_b32 v68, 16, v26
  v_and_b32 v69, 0xffff0000, v26
  v_lshlrev_b32 v70, 16, v27
  v_and_b32 v71, 0xffff0000, v27
  v_pk_add_f32 v[72:73], v[72:73], v[64:65]
  v_pk_add_f32 v[74:75], v[74:75], v[66:67]
  v_pk_add_f32 v[72:73], v[72:73], v[68:69]
  v_pk_add_f32 v[74:75], v[74:75], v[70:71]
  v_pk_add_f32 v[72:73], v[72:73], v[74:75]
  s_nop 0
  v_add_f32 v72, v72, v73
  s_nop 1
  v_add_f32 v72, v72, v72 row_ror:8
  s_nop 1
  v_add_f32 v72, v72, v72 row_ror:4
  s_nop 1
  v_add_f32 v72, v72, v72 row_ror:2
  s_nop 1
  v_add_f32 v72, v72, v72 row_ror:1
  v_mul_f32 v72, 0xbacccccd, v72
  v_pk_add_f32 v[80:81], v[32:33], v[72:73] op_sel_hi:[1,0]
  v_pk_add_f32 v[82:83], v[34:35], v[72:73] op_sel_hi:[1,0]
  v_pk_add_f32 v[84:85], v[36:37], v[72:73] op_sel_hi:[1,0]
  v_pk_add_f32 v[86:87], v[38:39], v[72:73] op_sel_hi:[1,0]
  v_pk_add_f32 v[88:89], v[40:41], v[72:73] op_sel_hi:[1,0]
  v_pk_add_f32 v[90:91], v[42:43], v[72:73] op_sel_hi:[1,0]
  v_pk_add_f32 v[92:93], v[44:45], v[72:73] op_sel_hi:[1,0]
  v_pk_add_f32 v[94:95], v[46:47], v[72:73] op_sel_hi:[1,0]
  v_pk_add_f32 v[96:97], v[48:49], v[72:73] op_sel_hi:[1,0]
  v_pk_add_f32 v[98:99], v[50:51], v[72:73] op_sel_hi:[1,0]
  v_pk_add_f32 v[100:101], v[52:53], v[72:73] op_sel_hi:[1,0]
  v_pk_add_f32 v[102:103], v[54:55], v[72:73] op_sel_hi:[1,0]
  v_pk_add_f32 v[104:105], v[56:57], v[72:73] op_sel_hi:[1,0]
  v_pk_add_f32 v[106:107], v[58:59], v[72:73] op_sel_hi:[1,0]
  v_pk_add_f32 v[108:109], v[60:61], v[72:73] op_sel_hi:[1,0]
  v_pk_add_f32 v[110:111], v[62:63], v[72:73] op_sel_hi:[1,0]
  v_pk_add_f32 v[112:113], v[64:65], v[72:73] op_sel_hi:[1,0]
  v_pk_add_f32 v[114:115], v[66:67], v[72:73] op_sel_hi:[1,0]
  v_pk_add_f32 v[116:117], v[68:69], v[72:73] op_sel_hi:[1,0]
  v_pk_add_f32 v[118:119], v[70:71], v[72:73] op_sel_hi:[1,0]
  v_pk_mul_f32 v[74:75], v[80:81], v[80:81]
  v_pk_mul_f32 v[76:77], v[82:83], v[82:83]
  v_pk_fma_f32 v[74:75], v[84:85], v[84:85], v[74:75]
  v_pk_fma_f32 v[76:77], v[86:87], v[86:87], v[76:77]
  v_pk_fma_f32 v[74:75], v[88:89], v[88:89], v[74:75]
  v_pk_fma_f32 v[76:77], v[90:91], v[90:91], v[76:77]
  v_pk_fma_f32 v[74:75], v[92:93], v[92:93], v[74:75]
  v_pk_fma_f32 v[76:77], v[94:95], v[94:95], v[76:77]
  v_pk_fma_f32 v[74:75], v[96:97], v[96:97], v[74:75]
  v_pk_fma_f32 v[76:77], v[98:99], v[98:99], v[76:77]
  v_pk_fma_f32 v[74:75], v[100:101], v[100:101], v[74:75]
  v_pk_fma_f32 v[76:77], v[102:103], v[102:103], v[76:77]
  v_pk_fma_f32 v[74:75], v[104:105], v[104:105], v[74:75]
  v_pk_fma_f32 v[76:77], v[106:107], v[106:107], v[76:77]
  v_pk_fma_f32 v[74:75], v[108:109], v[108:109], v[74:75]
  v_pk_fma_f32 v[76:77], v[110:111], v[110:111], v[76:77]
  v_pk_fma_f32 v[74:75], v[112:113], v[112:113], v[74:75]
  v_pk_fma_f32 v[76:77], v[114:115], v[114:115], v[76:77]
  v_pk_fma_f32 v[74:75], v[116:117], v[116:117], v[74:75]
  v_pk_fma_f32 v[76:77], v[118:119], v[118:119], v[76:77]
  v_cvt_pk_bf16_f32 v78, -v72, -v72
  v_pk_add_f32 v[74:75], v[74:75], v[76:77]
  v_and_b32 v78, 0xffff0000, v78
  v_add_f32 v74, v74, v75
  v_pk_add_f32 v[32:33], v[32:33], v[78:79] op_sel_hi:[1,0] neg_lo:[0,1] neg_hi:[0,1]
  v_cvt_pk_bf16_f32 v33, v32, v33
  v_lshlrev_b32 v32, 16, v33
  v_and_b32 v33, 0xffff0000, v33
  v_add_f32 v74, v74, v74 row_ror:8
  v_pk_add_f32 v[34:35], v[34:35], v[78:79] op_sel_hi:[1,0] neg_lo:[0,1] neg_hi:[0,1]
  v_cvt_pk_bf16_f32 v35, v34, v35
  v_lshlrev_b32 v34, 16, v35
  v_and_b32 v35, 0xffff0000, v35
  v_add_f32 v74, v74, v74 row_ror:4
  v_pk_add_f32 v[36:37], v[36:37], v[78:79] op_sel_hi:[1,0] neg_lo:[0,1] neg_hi:[0,1]
  v_cvt_pk_bf16_f32 v37, v36, v37
  v_lshlrev_b32 v36, 16, v37
  v_and_b32 v37, 0xffff0000, v37
  v_add_f32 v74, v74, v74 row_ror:2
  v_pk_add_f32 v[38:39], v[38:39], v[78:79] op_sel_hi:[1,0] neg_lo:[0,1] neg_hi:[0,1]
  v_cvt_pk_bf16_f32 v39, v38, v39
  v_lshlrev_b32 v38, 16, v39
  v_and_b32 v39, 0xffff0000, v39
  v_add_f32 v74, v74, v74 row_ror:1
  v_pk_add_f32 v[40:41], v[40:41], v[78:79] op_sel_hi:[1,0] neg_lo:[0,1] neg_hi:[0,1]
  v_cvt_pk_bf16_f32 v41, v40, v41
  v_lshlrev_b32 v40, 16, v41
  v_and_b32 v41, 0xffff0000, v41
  v_mul_f32 v74, 0x3acccccd, v74
  v_pk_add_f32 v[42:43], v[42:43], v[78:79] op_sel_hi:[1,0] neg_lo:[0,1] neg_hi:[0,1]
  v_cvt_pk_bf16_f32 v43, v42, v43
  v_lshlrev_b32 v42, 16, v43
  v_and_b32 v43, 0xffff0000, v43
  v_cvt_pk_bf16_f32 v74, v74, v74
  v_pk_add_f32 v[44:45], v[44:45], v[78:79] op_sel_hi:[1,0] neg_lo:[0,1] neg_hi:[0,1]
  v_cvt_pk_bf16_f32 v45, v44, v45
  v_lshlrev_b32 v44, 16, v45
  v_and_b32 v45, 0xffff0000, v45
  v_lshlrev_b32 v74, 16, v74
  v_pk_add_f32 v[46:47], v[46:47], v[78:79] op_sel_hi:[1,0] neg_lo:[0,1] neg_hi:[0,1]
  v_cvt_pk_bf16_f32 v47, v46, v47
  v_lshlrev_b32 v46, 16, v47
  v_and_b32 v47, 0xffff0000, v47
  v_add_f32 v74, 0x3727c5ac, v74
  v_pk_add_f32 v[48:49], v[48:49], v[78:79] op_sel_hi:[1,0] neg_lo:[0,1] neg_hi:[0,1]
  v_cvt_pk_bf16_f32 v49, v48, v49
  v_lshlrev_b32 v48, 16, v49
  v_and_b32 v49, 0xffff0000, v49
  v_cvt_pk_bf16_f32 v74, v74, v74
  v_pk_add_f32 v[50:51], v[50:51], v[78:79] op_sel_hi:[1,0] neg_lo:[0,1] neg_hi:[0,1]
  v_cvt_pk_bf16_f32 v51, v50, v51
  v_lshlrev_b32 v50, 16, v51
  v_and_b32 v51, 0xffff0000, v51
  v_lshlrev_b32 v74, 16, v74
  v_pk_add_f32 v[52:53], v[52:53], v[78:79] op_sel_hi:[1,0] neg_lo:[0,1] neg_hi:[0,1]
  v_cvt_pk_bf16_f32 v53, v52, v53
  v_lshlrev_b32 v52, 16, v53
  v_and_b32 v53, 0xffff0000, v53
  v_sqrt_f32 v74, v74
  v_pk_add_f32 v[54:55], v[54:55], v[78:79] op_sel_hi:[1,0] neg_lo:[0,1] neg_hi:[0,1]
  v_cvt_pk_bf16_f32 v55, v54, v55
  v_lshlrev_b32 v54, 16, v55
  v_and_b32 v55, 0xffff0000, v55
  v_cvt_pk_bf16_f32 v74, v74, v74
  v_pk_add_f32 v[56:57], v[56:57], v[78:79] op_sel_hi:[1,0] neg_lo:[0,1] neg_hi:[0,1]
  v_cvt_pk_bf16_f32 v57, v56, v57
  v_lshlrev_b32 v56, 16, v57
  v_and_b32 v57, 0xffff0000, v57
  v_lshlrev_b32 v74, 16, v74
  v_pk_add_f32 v[58:59], v[58:59], v[78:79] op_sel_hi:[1,0] neg_lo:[0,1] neg_hi:[0,1]
  v_cvt_pk_bf16_f32 v59, v58, v59
  v_lshlrev_b32 v58, 16, v59
  v_and_b32 v59, 0xffff0000, v59
  v_rcp_f32 v79, v74
  v_pk_add_f32 v[60:61], v[60:61], v[78:79] op_sel_hi:[1,0] neg_lo:[0,1] neg_hi:[0,1]
  v_cvt_pk_bf16_f32 v61, v60, v61
  v_lshlrev_b32 v60, 16, v61
  v_and_b32 v61, 0xffff0000, v61
  v_pk_add_f32 v[62:63], v[62:63], v[78:79] op_sel_hi:[1,0] neg_lo:[0,1] neg_hi:[0,1]
  v_cvt_pk_bf16_f32 v63, v62, v63
  v_lshlrev_b32 v62, 16, v63
  v_and_b32 v63, 0xffff0000, v63
  v_pk_add_f32 v[64:65], v[64:65], v[78:79] op_sel_hi:[1,0] neg_lo:[0,1] neg_hi:[0,1]
  v_cvt_pk_bf16_f32 v65, v64, v65
  v_lshlrev_b32 v64, 16, v65
  v_and_b32 v65, 0xffff0000, v65
  v_pk_add_f32 v[66:67], v[66:67], v[78:79] op_sel_hi:[1,0] neg_lo:[0,1] neg_hi:[0,1]
  v_cvt_pk_bf16_f32 v67, v66, v67
  v_lshlrev_b32 v66, 16, v67
  v_and_b32 v67, 0xffff0000, v67
  v_pk_add_f32 v[68:69], v[68:69], v[78:79] op_sel_hi:[1,0] neg_lo:[0,1] neg_hi:[0,1]
  v_cvt_pk_bf16_f32 v69, v68, v69
  v_lshlrev_b32 v68, 16, v69
  v_and_b32 v69, 0xffff0000, v69
  v_pk_add_f32 v[70:71], v[70:71], v[78:79] op_sel_hi:[1,0] neg_lo:[0,1] neg_hi:[0,1]
  v_cvt_pk_bf16_f32 v71, v70, v71
  v_lshlrev_b32 v70, 16, v71
  v_and_b32 v71, 0xffff0000, v71
  v_pk_mul_f32 v[32:33], v[32:33], v[78:79] op_sel:[0,1] op_sel_hi:[1,1]
  v_pk_mul_f32 v[34:35], v[34:35], v[78:79] op_sel:[0,1] op_sel_hi:[1,1]
  v_pk_mul_f32 v[36:37], v[36:37], v[78:79] op_sel:[0,1] op_sel_hi:[1,1]
  v_pk_mul_f32 v[38:39], v[38:39], v[78:79] op_sel:[0,1] op_sel_hi:[1,1]
  v_pk_mul_f32 v[40:41], v[40:41], v[78:79] op_sel:[0,1] op_sel_hi:[1,1]
  v_pk_mul_f32 v[42:43], v[42:43], v[78:79] op_sel:[0,1] op_sel_hi:[1,1]
  v_pk_mul_f32 v[44:45], v[44:45], v[78:79] op_sel:[0,1] op_sel_hi:[1,1]
  v_pk_mul_f32 v[46:47], v[46:47], v[78:79] op_sel:[0,1] op_sel_hi:[1,1]
  v_pk_mul_f32 v[48:49], v[48:49], v[78:79] op_sel:[0,1] op_sel_hi:[1,1]
  v_pk_mul_f32 v[50:51], v[50:51], v[78:79] op_sel:[0,1] op_sel_hi:[1,1]
  v_pk_mul_f32 v[52:53], v[52:53], v[78:79] op_sel:[0,1] op_sel_hi:[1,1]
  v_pk_mul_f32 v[54:55], v[54:55], v[78:79] op_sel:[0,1] op_sel_hi:[1,1]
  v_pk_mul_f32 v[56:57], v[56:57], v[78:79] op_sel:[0,1] op_sel_hi:[1,1]
  v_pk_mul_f32 v[58:59], v[58:59], v[78:79] op_sel:[0,1] op_sel_hi:[1,1]
  v_pk_mul_f32 v[60:61], v[60:61], v[78:79] op_sel:[0,1] op_sel_hi:[1,1]
  v_pk_mul_f32 v[62:63], v[62:63], v[78:79] op_sel:[0,1] op_sel_hi:[1,1]
  v_pk_mul_f32 v[64:65], v[64:65], v[78:79] op_sel:[0,1] op_sel_hi:[1,1]
  v_pk_mul_f32 v[66:67], v[66:67], v[78:79] op_sel:[0,1] op_sel_hi:[1,1]
  v_pk_mul_f32 v[68:69], v[68:69], v[78:79] op_sel:[0,1] op_sel_hi:[1,1]
  v_pk_mul_f32 v[70:71], v[70:71], v[78:79] op_sel:[0,1] op_sel_hi:[1,1]
  v_cvt_pk_bf16_f32 v33, v32, v33
  v_lshlrev_b32 v32, 16, v33
  v_and_b32 v33, 0xffff0000, v33
  v_cvt_pk_f16_f32 v8, v32, v33
  v_cvt_pk_bf16_f32 v35, v34, v35
  v_lshlrev_b32 v34, 16, v35
  v_and_b32 v35, 0xffff0000, v35
  v_cvt_pk_f16_f32 v9, v34, v35
  v_cvt_pk_bf16_f32 v37, v36, v37
  v_lshlrev_b32 v36, 16, v37
  v_and_b32 v37, 0xffff0000, v37
  v_cvt_pk_f16_f32 v10, v36, v37
  v_cvt_pk_bf16_f32 v39, v38, v39
  v_lshlrev_b32 v38, 16, v39
  v_and_b32 v39, 0xffff0000, v39
  v_cvt_pk_f16_f32 v11, v38, v39
  ds_write_b128 v4, v[8:11] offset:0
  v_cvt_pk_bf16_f32 v41, v40, v41
  v_lshlrev_b32 v40, 16, v41
  v_and_b32 v41, 0xffff0000, v41
  v_cvt_pk_f16_f32 v12, v40, v41
  v_cvt_pk_bf16_f32 v43, v42, v43
  v_lshlrev_b32 v42, 16, v43
  v_and_b32 v43, 0xffff0000, v43
  v_cvt_pk_f16_f32 v13, v42, v43
  v_cvt_pk_bf16_f32 v45, v44, v45
  v_lshlrev_b32 v44, 16, v45
  v_and_b32 v45, 0xffff0000, v45
  v_cvt_pk_f16_f32 v14, v44, v45
  v_cvt_pk_bf16_f32 v47, v46, v47
  v_lshlrev_b32 v46, 16, v47
  v_and_b32 v47, 0xffff0000, v47
  v_cvt_pk_f16_f32 v15, v46, v47
  ds_write_b128 v4, v[12:15] offset:256
  v_cvt_pk_bf16_f32 v49, v48, v49
  v_lshlrev_b32 v48, 16, v49
  v_and_b32 v49, 0xffff0000, v49
  v_cvt_pk_f16_f32 v16, v48, v49
  v_cvt_pk_bf16_f32 v51, v50, v51
  v_lshlrev_b32 v50, 16, v51
  v_and_b32 v51, 0xffff0000, v51
  v_cvt_pk_f16_f32 v17, v50, v51
  v_cvt_pk_bf16_f32 v53, v52, v53
  v_lshlrev_b32 v52, 16, v53
  v_and_b32 v53, 0xffff0000, v53
  v_cvt_pk_f16_f32 v18, v52, v53
  v_cvt_pk_bf16_f32 v55, v54, v55
  v_lshlrev_b32 v54, 16, v55
  v_and_b32 v55, 0xffff0000, v55
  v_cvt_pk_f16_f32 v19, v54, v55
  ds_write_b128 v4, v[16:19] offset:512
  v_cvt_pk_bf16_f32 v57, v56, v57
  v_lshlrev_b32 v56, 16, v57
  v_and_b32 v57, 0xffff0000, v57
  v_cvt_pk_f16_f32 v20, v56, v57
  v_cvt_pk_bf16_f32 v59, v58, v59
  v_lshlrev_b32 v58, 16, v59
  v_and_b32 v59, 0xffff0000, v59
  v_cvt_pk_f16_f32 v21, v58, v59
  v_cvt_pk_bf16_f32 v61, v60, v61
  v_lshlrev_b32 v60, 16, v61
  v_and_b32 v61, 0xffff0000, v61
  v_cvt_pk_f16_f32 v22, v60, v61
  v_cvt_pk_bf16_f32 v63, v62, v63
  v_lshlrev_b32 v62, 16, v63
  v_and_b32 v63, 0xffff0000, v63
  v_cvt_pk_f16_f32 v23, v62, v63
  ds_write_b128 v4, v[20:23] offset:768
  v_cvt_pk_bf16_f32 v65, v64, v65
  v_lshlrev_b32 v64, 16, v65
  v_and_b32 v65, 0xffff0000, v65
  v_cvt_pk_f16_f32 v24, v64, v65
  v_cvt_pk_bf16_f32 v67, v66, v67
  v_lshlrev_b32 v66, 16, v67
  v_and_b32 v67, 0xffff0000, v67
  v_cvt_pk_f16_f32 v25, v66, v67
  v_cvt_pk_bf16_f32 v69, v68, v69
  v_lshlrev_b32 v68, 16, v69
  v_and_b32 v69, 0xffff0000, v69
  v_cvt_pk_f16_f32 v26, v68, v69
  v_cvt_pk_bf16_f32 v71, v70, v71
  v_lshlrev_b32 v70, 16, v71
  v_and_b32 v71, 0xffff0000, v71
  v_cvt_pk_f16_f32 v27, v70, v71
  ds_write_b128 v4, v[24:27] offset:1024
  s_movk_i32 s26, 0x1000
  v_mov_b32 v120, 0
  v_mov_b32 v121, 0
  v_readfirstlane_b32 s19, v0
  s_cmp_lg_u32 s19, 0
  s_cbranch_scc1 k12_kernel_noin
  global_load_dword v121, v120, s[28:29] sc1
k12_kernel_noin:
  v_cmp_eq_u32 vcc, 0, v2
  s_and_saveexec_b64 s[24:25], vcc
  buffer_store_dwordx2 v[78:79], v7, s[20:23], 0 offen
  s_mov_b64 exec, s[24:25]

  s_waitcnt lgkmcnt(0)
  s_barrier
  ds_read_b64_tr_b16 v[32:33], v5 offset:0
  ds_read_b64_tr_b16 v[34:35], v5 offset:5248
  ds_read_b64_tr_b16 v[36:37], v5 offset:64
  ds_read_b64_tr_b16 v[38:39], v5 offset:5312
  ds_read_b64_tr_b16 v[40:41], v5 offset:128
  ds_read_b64_tr_b16 v[42:43], v5 offset:5376
  ds_read_b64_tr_b16 v[44:45], v5 offset:192
  ds_read_b64_tr_b16 v[46:47], v5 offset:5440
  ds_read_b64_tr_b16 v[48:49], v5 offset:256
  ds_read_b64_tr_b16 v[50:51], v5 offset:5504
  s_waitcnt lgkmcnt(8)
  buffer_store_dwordx4 v[32:35], v6, s[12:15], 0 offen offset:0 sc1
  s_waitcnt lgkmcnt(6)
  buffer_store_dwordx4 v[36:39], v6, s[12:15], 0 offen offset:1024 sc1
  s_waitcnt lgkmcnt(4)
  buffer_store_dwordx4 v[40:43], v6, s[12:15], 0 offen offset:2048 sc1
  s_waitcnt lgkmcnt(2)
  buffer_store_dwordx4 v[44:47], v6, s[12:15], 0 offen offset:3072 sc1
  s_waitcnt lgkmcnt(0)
  buffer_store_dwordx4 v[48:51], v6, s[12:15], s26 offen offset:0 sc1

  s_waitcnt vmcnt(0)

  s_barrier

  v_cmp_gt_u32 vcc, 16, v0
  s_and_saveexec_b64 s[24:25], vcc
  s_cbranch_execz k12_kernel_done
  s_mov_b32 s21, 200000
k12_kernel_ipoll:
  v_cmp_eq_u32 vcc, 0, v121
  s_sub_u32 s21, s21, 1
  s_cmp_lt_i32 s21, 1
  s_cbranch_scc1 k12_kernel_iok
  s_cbranch_vccz k12_kernel_iok
  s_sleep 8
  global_load_dword v121, v120, s[28:29] sc1
  s_waitcnt vmcnt(0)
  s_branch k12_kernel_ipoll
k12_kernel_iok:
  s_and_b32 s17, s2, 7
  s_lshl_b32 s17, s17, 7
  s_lshr_b32 s18, s2, 3
  s_lshl_b32 s18, s18, 2
  s_add_u32 s17, s17, s18
  v_mul_u32_u24 v1, 1024, v0
  v_add_u32 v1, s17, v1
  v_mov_b32 v2, 1
  global_store_dword v1, v2, s[30:31] sc1
  s_cmp_ge_u32 s2, 32
  s_cbranch_scc1 k12_kernel_nobird
  s_lshl_b32 s17, s2, 7
  s_add_u32 s17, s17, 16384
  v_mov_b32 v1, s17
  global_store_dword v1, v2, s[30:31] sc1
k12_kernel_nobird:
  s_endpgm
k12_kernel_kgen:

  s_sub_u32 s16, s2, 128
  s_and_b32 s17, s16, 7
  s_mul_i32 s17, s17, 80
  s_lshr_b32 s16, s16, 3
  s_add_u32 s16, s16, s17
  s_load_dwordx4 s[4:7], s[0:1], 8
  s_load_dwordx4 s[8:11], s[0:1], 24
  s_load_dwordx2 s[12:13], s[0:1], 40
  s_load_dwordx4 s[36:39], s[0:1], 104
  s_load_dwordx2 s[40:41], s[0:1], 64
  s_load_dwordx2 s[50:51], s[0:1], 80
  s_getpc_b64 s[18:19]
  s_add_u32 s18, s18, kimg_idx@rel32@lo+4
  s_addc_u32 s19, s19, kimg_idx@rel32@hi+12
  v_lshrrev_b32 v1, 6, v0
  v_lshlrev_b32 v2, 4, v0
  v_readfirstlane_b32 s3, v1
  global_load_dwordx4 v[60:63], v2, s[18:19]
  v_add_u32 v2, 0x1000, v2
  global_load_dwordx4 v[64:67], v2, s[18:19]
  v_and_b32 v1, 127, v0
  s_lshl_b32 s17, s16, 8
  v_lshl_add_u32 v2, v1, 1, s17
  v_xor_b32 v3, 128, v2
  s_lshl_b32 s20, s16, 1
  s_and_b32 s21, s20, 0xfffffffc
  s_waitcnt lgkmcnt(0)
  s_load_dword s22, s[12:13], s21
  global_load_ushort v4, v2, s[4:5]
  global_load_ushort v5, v2, s[6:7]
  global_load_ushort v6, v2, s[8:9]
  global_load_ushort v7, v2, s[10:11]
  global_load_ushort v8, v3, s[8:9]
  global_load_ushort v9, v3, s[10:11]
  v_lshlrev_b32 v1, 2, v1
  v_and_b32 v13, 63, v0
  v_and_b32 v14, 15, v0
  v_bfe_u32 v15, v0, 4, 2
  v_lshlrev_b32 v116, 4, v0
  v_lshlrev_b32 v117, 4, v13
  v_lshrrev_b32 v118, 1, v0
  v_mul_u32_u24 v118, 20608, v118
  v_and_b32 v51, 1, v0
  v_lshl_add_u32 v118, v51, 4, v118
  s_lshl_b32 s29, s16, 5
  v_add_u32 v118, s29, v118
  v_mov_b32 v110, v118
  v_subrev_u32 v51, 20584, v118
  v_cmp_eq_u32 vcc, 0, v13
  v_add_u32 v55, 20592, v118
  v_mov_b32 v56, 0x40000000
  v_cndmask_b32 v110, v110, v51, vcc
  v_cmp_eq_u32 vcc, 63, v13
  s_nop 1
  v_cndmask_b32 v110, v110, v55, vcc
  v_cmp_eq_u32 vcc, 0, v0
  s_nop 1
  v_cndmask_b32 v110, v110, v56, vcc
  v_mul_u32_u24 v121, 544, v14
  v_lshl_add_u32 v121, v15, 4, v121
  s_mul_i32 s30, s3, 8704
  v_add_u32 v120, s30, v121
  v_mul_u32_u24 v122, 192, v14
  v_lshl_add_u32 v122, v15, 4, v122
  s_lshl_b32 s30, s3, 6
  v_add_u32 v122, s30, v122
  v_mov_b32 v127, 0
  s_and_b32 s30, s2, 31
  s_lshl_b32 s30, s30, 7
  s_add_u32 s30, s30, 16384
  v_mov_b32 v111, s30
  v_mov_b32 v123, 0
  v_mov_b32 v119, 0
  v_sub_u32 v48, 15, v14
  v_and_b32 v49, 3, v48
  v_and_b32 v50, 12, v48
  v_and_b32 v52, 1, v15
  v_lshrrev_b32 v53, 1, v15
  s_cmp_ge_u32 s3, 2
  s_cbranch_scc1 k12_kernel_aBC
  v_lshlrev_b32 v51, 5, v14
  v_lshl_add_u32 v51, v15, 4, v51
  v_add_u32 v112, 6688, v51
  v_lshl_add_u32 v51, v52, 4, v14
  v_mul_u32_u24 v119, 20608, v51
  v_lshl_add_u32 v119, v53, 4, v119
  v_add_u32 v119, s29, v119
  v_mul_u32_u24 v51, 704, v49
  v_lshl_add_u32 v51, v50, 1, v51
  v_lshl_add_u32 v113, v15, 4, v51
  s_branch k12_kernel_adone
k12_kernel_aBC:
  v_lshlrev_b32 v54, 4, v52
  v_bfe_u32 v56, v0, 2, 2
  v_lshl_add_u32 v56, v52, 3, v56
  v_and_b32 v57, 3, v0
  v_lshlrev_b32 v57, 3, v57
  s_cmp_eq_u32 s3, 3
  s_cbranch_scc1 k12_kernel_aC
  v_lshlrev_b32 v51, 3, v48
  v_mul_u32_u24 v55, 384, v53
  v_add3_u32 v113, v51, v55, v54
  v_mul_u32_u24 v51, 4224, v53
  v_mul_u32_u24 v55, 8, v56
  v_add3_u32 v51, v51, v55, v57
  v_add_u32 v112, 20960, v51
  s_branch k12_kernel_adone
k12_kernel_aC:
  v_and_b32 v51, 1, v48
  v_mul_u32_u24 v51, 576, v51
  v_and_b32 v55, 14, v48
  v_lshl_add_u32 v51, v55, 2, v51
  v_mul_u32_u24 v55, 256, v53
  v_add3_u32 v113, v51, v55, v54
  v_mul_u32_u24 v51, 448, v49
  v_lshl_add_u32 v51, v50, 1, v51
  v_mul_u32_u24 v55, 192, v53
  v_add3_u32 v114, v51, v55, v54
  v_mul_u32_u24 v51, 4360, v53
  v_mul_u32_u24 v55, 16, v56
  v_add3_u32 v51, v51, v55, v57
  v_add_u32 v112, 16464, v51
  v_mul_u32_u24 v51, 2560, v53
  v_mul_u32_u24 v55, 32, v56
  v_add3_u32 v51, v51, v55, v57
  v_add_u32 v115, 11328, v51
  v_lshrrev_b32 v123, 3, v13
  v_lshlrev_b32 v123, 7, v123
  v_and_b32 v51, 7, v13
  v_lshl_add_u32 v123, v51, 3, v123
  s_and_b32 s30, s2, 15
  s_mul_i32 s30, s30, 1024
  v_add_u32 v123, s30, v123
k12_kernel_adone:
  s_add_u32 s8, s38, 0
  s_addc_u32 s9, s39, 0
  s_mov_b32 s10, 2637824
  s_mov_b32 s11, 0x00020000
  s_add_u32 s30, s38, 30408704
  s_addc_u32 s31, s39, 0
  s_add_u32 s32, s38, 4194304
  s_addc_u32 s33, s39, 0
  s_mov_b32 s34, 2637824
  s_mov_b32 s35, 0x00020000
  s_waitcnt vmcnt(6)
  v_and_b32 v68, 0xffff, v60
  v_lshrrev_b32 v69, 16, v60
  v_and_b32 v70, 0xffff, v61
  v_lshrrev_b32 v71, 16, v61
  v_and_b32 v72, 0xffff, v62
  v_lshrrev_b32 v73, 16, v62
  v_and_b32 v74, 0xffff, v63
  v_lshrrev_b32 v75, 16, v63
  v_and_b32 v76, 0xffff, v64
  v_lshrrev_b32 v77, 16, v64
  v_and_b32 v78, 0xffff, v65
  v_lshrrev_b32 v79, 16, v65
  v_and_b32 v80, 0xffff, v66
  v_lshrrev_b32 v81, 16, v66
  v_and_b32 v82, 0xffff, v67
  v_lshrrev_b32 v83, 16, v67
  s_waitcnt lgkmcnt(0)
  s_and_b32 s20, s20, 2
  s_lshl_b32 s20, s20, 3
  s_lshr_b32 s22, s22, s20
  s_lshl_b32 s22, s22, 16
  s_mov_b32 s23, 0x3fb8aa3b
  s_mov_b32 s24, 0x32a57060
  v_mov_b32 v10, s22
  v_mul_f32 v11, s23, v10
  v_fma_f32 v12, v10, s23, -v11
  v_fma_f32 v12, v10, s24, v12
  v_exp_f32 v11, v11
  v_mul_f32 v12, 0x3f317218, v12
  v_fma_f32 v10, v11, v12, v11
  v_cvt_pk_bf16_f32 v10, v10, v10
  v_lshlrev_b32 v10, 16, v10
  s_waitcnt vmcnt(5)
  v_lshlrev_b32 v4, 16, v4
  v_mul_f32 v11, s23, v4
  v_fma_f32 v12, v4, s23, -v11
  v_fma_f32 v12, v4, s24, v12
  v_exp_f32 v11, v11
  v_mul_f32 v12, 0x3f317218, v12
  v_fma_f32 v4, v11, v12, v11
  v_cvt_pk_bf16_f32 v4, v4, v4
  v_lshlrev_b32 v4, 16, v4
  v_mul_f32 v4, v4, v10
  v_mul_f32 v4, 0xbfb8aa3b, v4
  s_waitcnt vmcnt(0)
  v_lshlrev_b32 v5, 16, v5
  v_mul_f32 v5, v5, v10
  v_mul_f32 v5, 0x3e22f983, v5
  v_lshlrev_b32 v6, 16, v6
  v_lshlrev_b32 v7, 16, v7
  v_lshlrev_b32 v8, 16, v8
  v_lshlrev_b32 v9, 16, v9
  v_max3_f32 v11, |v6|, |v7|, |v8|
  v_max_f32 v11, v11, |v9|
  v_mul_f32 v11, v11, v10
  s_nop 1
  v_max_f32 v11, v11, v11 row_ror:8
  s_nop 1
  v_max_f32 v11, v11, v11 row_ror:4
  s_nop 1
  v_max_f32 v11, v11, v11 row_ror:2
  s_nop 1
  v_max_f32 v11, v11, v11 row_ror:1
  s_nop 0
  v_readlane_b32 s25, v11, 0
  v_readlane_b32 s26, v11, 16
  v_readlane_b32 s27, v11, 32
  v_readlane_b32 s28, v11, 48
  v_mul_f32 v6, v6, v10
  v_mul_f32 v7, v7, v10
  s_max_u32 s25, s25, s26
  s_max_u32 s27, s27, s28
  s_max_u32 s25, s25, s27
  s_lshr_b32 s25, s25, 23
  s_max_u32 s25, s25, 1
  s_min_u32 s25, s25, 253
  s_sub_u32 s26, 254, s25
  s_lshl_b32 s26, s26, 23
  s_add_u32 s27, s25, 1
  s_lshl_b32 s27, s27, 23
  v_mul_f32 v6, s26, v6
  v_mul_f32 v7, s26, v7
  s_cmp_ge_u32 s3, 2
  s_cbranch_scc1 k12_kernel_part1
  v_exp_f32 v44, v4
  v_fract_f32 v45, v5
  v_cos_f32 v12, v45
  v_sin_f32 v13, v45
  s_nop 0
  v_mul_f32 v12, v12, v44
  v_mul_f32 v13, v13, v44
  v_mul_f32 v40, 0x43000000, v4
  v_mul_f32 v41, 0x43000000, v5
  v_exp_f32 v40, v40
  v_fract_f32 v41, v41
  v_cos_f32 v28, v41
  v_sin_f32 v29, v41
  s_nop 0
  v_mul_f32 v28, v28, v40
  v_mul_f32 v29, v29, v40
  v_cvt_pk_f16_f32 v48, v6, -v7
  ds_write_b32 v1, v48 offset:0
  v_pk_mul_f32 v[52:53], v[12:13], v[12:13] op_sel:[1,1] op_sel_hi:[1,0]
  v_pk_fma_f32 v[14:15], v[12:13], v[12:13], v[52:53] op_sel_hi:[0,1,1] neg_lo:[0,0,1]
  v_pk_mul_f32 v[54:55], v[6:7], v[28:29] op_sel:[1,1] op_sel_hi:[1,0]
  v_pk_fma_f32 v[30:31], v[6:7], v[28:29], v[54:55] op_sel_hi:[0,1,1] neg_lo:[0,0,1]
  v_pk_mul_f32 v[56:57], v[14:15], v[12:13] op_sel:[1,1] op_sel_hi:[1,0]
  v_pk_fma_f32 v[16:17], v[14:15], v[12:13], v[56:57] op_sel_hi:[0,1,1] neg_lo:[0,0,1]
  v_pk_mul_f32 v[58:59], v[14:15], v[14:15] op_sel:[1,1] op_sel_hi:[1,0]
  v_pk_fma_f32 v[18:19], v[14:15], v[14:15], v[58:59] op_sel_hi:[0,1,1] neg_lo:[0,0,1]
  v_pk_mul_f32 v[52:53], v[30:31], v[28:29] op_sel:[1,1] op_sel_hi:[1,0]
  v_pk_fma_f32 v[32:33], v[30:31], v[28:29], v[52:53] op_sel_hi:[0,1,1] neg_lo:[0,0,1]
  v_cvt_pk_f16_f32 v49, v30, -v31
  ds_write_b32 v1, v49 offset:4352
  v_pk_mul_f32 v[54:55], v[18:19], v[12:13] op_sel:[1,1] op_sel_hi:[1,0]
  v_pk_fma_f32 v[20:21], v[18:19], v[12:13], v[54:55] op_sel_hi:[0,1,1] neg_lo:[0,0,1]
  v_pk_mul_f32 v[56:57], v[18:19], v[14:15] op_sel:[1,1] op_sel_hi:[1,0]
  v_pk_fma_f32 v[22:23], v[18:19], v[14:15], v[56:57] op_sel_hi:[0,1,1] neg_lo:[0,0,1]
  v_pk_mul_f32 v[58:59], v[18:19], v[16:17] op_sel:[1,1] op_sel_hi:[1,0]
  v_pk_fma_f32 v[24:25], v[18:19], v[16:17], v[58:59] op_sel_hi:[0,1,1] neg_lo:[0,0,1]
  v_pk_mul_f32 v[52:53], v[18:19], v[18:19] op_sel:[1,1] op_sel_hi:[1,0]
  v_pk_fma_f32 v[26:27], v[18:19], v[18:19], v[52:53] op_sel_hi:[0,1,1] neg_lo:[0,0,1]
  v_pk_mul_f32 v[54:55], v[32:33], v[28:29] op_sel:[1,1] op_sel_hi:[1,0]
  v_pk_fma_f32 v[34:35], v[32:33], v[28:29], v[54:55] op_sel_hi:[0,1,1] neg_lo:[0,0,1]
  v_cvt_pk_f16_f32 v50, v32, -v33
  ds_write_b32 v1, v50 offset:8704
  v_cvt_pk_f16_f32 v51, v34, -v35
  ds_write_b32 v1, v51 offset:10880
  v_pk_mul_f32 v[56:57], v[6:7], v[12:13] op_sel:[1,1] op_sel_hi:[1,0]
  v_pk_fma_f32 v[36:37], v[6:7], v[12:13], v[56:57] op_sel_hi:[0,1,1] neg_lo:[0,0,1]
  v_cvt_pk_f16_f32 v48, v36, -v37
  ds_write_b32 v1, v48 offset:544
  v_pk_mul_f32 v[58:59], v[30:31], v[12:13] op_sel:[1,1] op_sel_hi:[1,0]
  v_pk_fma_f32 v[38:39], v[30:31], v[12:13], v[58:59] op_sel_hi:[0,1,1] neg_lo:[0,0,1]
  v_cvt_pk_f16_f32 v49, v38, -v39
  ds_write_b32 v1, v49 offset:4896
  v_pk_mul_f32 v[52:53], v[6:7], v[14:15] op_sel:[1,1] op_sel_hi:[1,0]
  v_pk_fma_f32 v[40:41], v[6:7], v[14:15], v[52:53] op_sel_hi:[0,1,1] neg_lo:[0,0,1]
  v_cvt_pk_f16_f32 v50, v40, -v41
  ds_write_b32 v1, v50 offset:1088
  v_pk_mul_f32 v[54:55], v[30:31], v[14:15] op_sel:[1,1] op_sel_hi:[1,0]
  v_pk_fma_f32 v[42:43], v[30:31], v[14:15], v[54:55] op_sel_hi:[0,1,1] neg_lo:[0,0,1]
  v_cvt_pk_f16_f32 v51, v42, -v43
  ds_write_b32 v1, v51 offset:5440
  v_pk_mul_f32 v[56:57], v[6:7], v[16:17] op_sel:[1,1] op_sel_hi:[1,0]
  v_pk_fma_f32 v[36:37], v[6:7], v[16:17], v[56:57] op_sel_hi:[0,1,1] neg_lo:[0,0,1]
  v_cvt_pk_f16_f32 v48, v36, -v37
  ds_write_b32 v1, v48 offset:1632
  v_pk_mul_f32 v[58:59], v[30:31], v[16:17] op_sel:[1,1] op_sel_hi:[1,0]
  v_pk_fma_f32 v[38:39], v[30:31], v[16:17], v[58:59] op_sel_hi:[0,1,1] neg_lo:[0,0,1]
  v_cvt_pk_f16_f32 v49, v38, -v39
  ds_write_b32 v1, v49 offset:5984
  v_pk_mul_f32 v[52:53], v[6:7], v[18:19] op_sel:[1,1] op_sel_hi:[1,0]
  v_pk_fma_f32 v[40:41], v[6:7], v[18:19], v[52:53] op_sel_hi:[0,1,1] neg_lo:[0,0,1]
  v_cvt_pk_f16_f32 v50, v40, -v41
  ds_write_b32 v1, v50 offset:2176
  v_pk_mul_f32 v[54:55], v[30:31], v[18:19] op_sel:[1,1] op_sel_hi:[1,0]
  v_pk_fma_f32 v[42:43], v[30:31], v[18:19], v[54:55] op_sel_hi:[0,1,1] neg_lo:[0,0,1]
  v_cvt_pk_f16_f32 v51, v42, -v43
  ds_write_b32 v1, v51 offset:6528
  v_pk_mul_f32 v[56:57], v[6:7], v[20:21] op_sel:[1,1] op_sel_hi:[1,0]
  v_pk_fma_f32 v[36:37], v[6:7], v[20:21], v[56:57] op_sel_hi:[0,1,1] neg_lo:[0,0,1]
  v_cvt_pk_f16_f32 v48, v36, -v37
  ds_write_b32 v1, v48 offset:2720
  v_pk_mul_f32 v[58:59], v[30:31], v[20:21] op_sel:[1,1] op_sel_hi:[1,0]
  v_pk_fma_f32 v[38:39], v[30:31], v[20:21], v[58:59] op_sel_hi:[0,1,1] neg_lo:[0,0,1]
  v_cvt_pk_f16_f32 v49, v38, -v39
  ds_write_b32 v1, v49 offset:7072
  v_pk_mul_f32 v[52:53], v[6:7], v[22:23] op_sel:[1,1] op_sel_hi:[1,0]
  v_pk_fma_f32 v[40:41], v[6:7], v[22:23], v[52:53] op_sel_hi:[0,1,1] neg_lo:[0,0,1]
  v_cvt_pk_f16_f32 v50, v40, -v41
  ds_write_b32 v1, v50 offset:3264
  v_pk_mul_f32 v[54:55], v[30:31], v[22:23] op_sel:[1,1] op_sel_hi:[1,0]
  v_pk_fma_f32 v[42:43], v[30:31], v[22:23], v[54:55] op_sel_hi:[0,1,1] neg_lo:[0,0,1]
  v_cvt_pk_f16_f32 v51, v42, -v43
  ds_write_b32 v1, v51 offset:7616
  v_pk_mul_f32 v[56:57], v[6:7], v[24:25] op_sel:[1,1] op_sel_hi:[1,0]
  v_pk_fma_f32 v[36:37], v[6:7], v[24:25], v[56:57] op_sel_hi:[0,1,1] neg_lo:[0,0,1]
  v_cvt_pk_f16_f32 v48, v36, -v37
  ds_write_b32 v1, v48 offset:3808
  v_pk_mul_f32 v[58:59], v[30:31], v[24:25] op_sel:[1,1] op_sel_hi:[1,0]
  v_pk_fma_f32 v[38:39], v[30:31], v[24:25], v[58:59] op_sel_hi:[0,1,1] neg_lo:[0,0,1]
  v_cvt_pk_f16_f32 v49, v38, -v39
  ds_write_b32 v1, v49 offset:8160
  v_pk_mul_f32 v[52:53], v[32:33], v[14:15] op_sel:[1,1] op_sel_hi:[1,0]
  v_pk_fma_f32 v[40:41], v[32:33], v[14:15], v[52:53] op_sel_hi:[0,1,1] neg_lo:[0,0,1]
  v_cvt_pk_f16_f32 v50, v40, -v41
  ds_write_b32 v1, v50 offset:9248
  v_pk_mul_f32 v[54:55], v[34:35], v[14:15] op_sel:[1,1] op_sel_hi:[1,0]
  v_pk_fma_f32 v[42:43], v[34:35], v[14:15], v[54:55] op_sel_hi:[0,1,1] neg_lo:[0,0,1]
  v_cvt_pk_f16_f32 v51, v42, -v43
  ds_write_b32 v1, v51 offset:11424
  v_pk_mul_f32 v[56:57], v[32:33], v[18:19] op_sel:[1,1] op_sel_hi:[1,0]
  v_pk_fma_f32 v[36:37], v[32:33], v[18:19], v[56:57] op_sel_hi:[0,1,1] neg_lo:[0,0,1]
  v_cvt_pk_f16_f32 v48, v36, -v37
  ds_write_b32 v1, v48 offset:9792
  v_pk_mul_f32 v[58:59], v[34:35], v[18:19] op_sel:[1,1] op_sel_hi:[1,0]
  v_pk_fma_f32 v[38:39], v[34:35], v[18:19], v[58:59] op_sel_hi:[0,1,1] neg_lo:[0,0,1]
  v_cvt_pk_f16_f32 v49, v38, -v39
  ds_write_b32 v1, v49 offset:11968
  v_pk_mul_f32 v[52:53], v[32:33], v[22:23] op_sel:[1,1] op_sel_hi:[1,0]
  v_pk_fma_f32 v[40:41], v[32:33], v[22:23], v[52:53] op_sel_hi:[0,1,1] neg_lo:[0,0,1]
  v_cvt_pk_f16_f32 v50, v40, -v41
  ds_write_b32 v1, v50 offset:10336
  v_pk_mul_f32 v[54:55], v[34:35], v[22:23] op_sel:[1,1] op_sel_hi:[1,0]
  v_pk_fma_f32 v[42:43], v[34:35], v[22:23], v[54:55] op_sel_hi:[0,1,1] neg_lo:[0,0,1]
  v_cvt_pk_f16_f32 v51, v42, -v43
  ds_write_b32 v1, v51 offset:12512
  v_pk_add_f32 v[24:25], v[24:25], v[26:27] neg_lo:[0,1] neg_hi:[0,1]
  v_pk_add_f32 v[22:23], v[22:23], v[26:27] neg_lo:[0,1] neg_hi:[0,1]
  v_pk_mul_f32 v[56:57], v[30:31], v[24:25] op_sel:[1,1] op_sel_hi:[1,0]
  v_pk_fma_f32 v[36:37], v[30:31], v[24:25], v[56:57] op_sel_hi:[0,1,1] neg_lo:[0,0,1]
  v_cvt_pk_f16_f32 v48, v36, -v37
  ds_write_b32 v1, v48 offset:22304
  v_pk_mul_f32 v[58:59], v[34:35], v[22:23] op_sel:[1,1] op_sel_hi:[1,0]
  v_pk_fma_f32 v[38:39], v[34:35], v[22:23], v[58:59] op_sel_hi:[0,1,1] neg_lo:[0,0,1]
  v_cvt_pk_f16_f32 v49, v38, -v39
  ds_write_b32 v1, v49 offset:22848
  s_branch k12_kernel_tabdone
k12_kernel_part1:
  v_mul_f32 v44, 0x41000000, v4
  v_mul_f32 v45, 0x41000000, v5
  v_exp_f32 v44, v44
  v_fract_f32 v45, v45
  v_cos_f32 v12, v45
  v_sin_f32 v13, v45
  s_nop 0
  v_mul_f32 v12, v12, v44
  v_mul_f32 v13, v13, v44
  v_mul_f32 v40, 0x43000000, v4
  v_mul_f32 v41, 0x43000000, v5
  v_exp_f32 v40, v40
  v_fract_f32 v41, v41
  v_cos_f32 v28, v41
  v_sin_f32 v29, v41
  s_nop 0
  v_mul_f32 v28, v28, v40
  v_mul_f32 v29, v29, v40
  v_mul_f32 v44, 0x44000000, v4
  v_mul_f32 v45, 0x44000000, v5
  v_exp_f32 v44, v44
  v_fract_f32 v45, v45
  v_cos_f32 v30, v45
  v_sin_f32 v31, v45
  s_nop 0
  v_mul_f32 v30, v30, v44
  v_mul_f32 v31, v31, v44
  v_mul_f32 v40, 0x40800000, v4
  v_mul_f32 v41, 0x40800000, v5
  v_exp_f32 v40, v40
  v_fract_f32 v41, v41
  v_cos_f32 v32, v41
  v_sin_f32 v33, v41
  s_nop 0
  v_mul_f32 v32, v32, v40
  v_mul_f32 v33, v33, v40
  v_mov_b32 v48, 0x3c00
  ds_write_b32 v1, v48 offset:26112
  v_mov_b32 v49, 0
  ds_write_b32 v1, v49 offset:23936
  v_cvt_pk_f16_f32 v50, v12, v13
  ds_write_b32 v1, v50 offset:26656
  v_pk_mul_f32 v[52:53], v[12:13], v[12:13] op_sel:[1,1] op_sel_hi:[1,0]
  v_pk_fma_f32 v[14:15], v[12:13], v[12:13], v[52:53] op_sel_hi:[0,1,1] neg_lo:[0,0,1]
  v_pk_mul_f32 v[54:55], v[6:7], v[30:31] op_sel:[1,1] op_sel_hi:[1,0]
  v_pk_fma_f32 v[34:35], v[6:7], v[30:31], v[54:55] op_sel_hi:[0,1,1] neg_lo:[0,0,1]
  v_cvt_pk_f16_f32 v51, v14, v15
  ds_write_b32 v1, v51 offset:27200
  v_pk_mul_f32 v[56:57], v[14:15], v[12:13] op_sel:[1,1] op_sel_hi:[1,0]
  v_pk_fma_f32 v[20:21], v[14:15], v[12:13], v[56:57] op_sel_hi:[0,1,1] neg_lo:[0,0,1]
  v_pk_mul_f32 v[58:59], v[14:15], v[14:15] op_sel:[1,1] op_sel_hi:[1,0]
  v_pk_fma_f32 v[16:17], v[14:15], v[14:15], v[58:59] op_sel_hi:[0,1,1] neg_lo:[0,0,1]
  v_cvt_pk_f16_f32 v48, v20, v21
  ds_write_b32 v1, v48 offset:27744
  v_cvt_pk_f16_f32 v49, v16, v17
  ds_write_b32 v1, v49 offset:28288
  v_pk_mul_f32 v[52:53], v[16:17], v[12:13] op_sel:[1,1] op_sel_hi:[1,0]
  v_pk_fma_f32 v[22:23], v[16:17], v[12:13], v[52:53] op_sel_hi:[0,1,1] neg_lo:[0,0,1]
  v_pk_mul_f32 v[54:55], v[16:17], v[14:15] op_sel:[1,1] op_sel_hi:[1,0]
  v_pk_fma_f32 v[24:25], v[16:17], v[14:15], v[54:55] op_sel_hi:[0,1,1] neg_lo:[0,0,1]
  v_pk_mul_f32 v[56:57], v[16:17], v[20:21] op_sel:[1,1] op_sel_hi:[1,0]
  v_pk_fma_f32 v[26:27], v[16:17], v[20:21], v[56:57] op_sel_hi:[0,1,1] neg_lo:[0,0,1]
  v_pk_mul_f32 v[58:59], v[16:17], v[16:17] op_sel:[1,1] op_sel_hi:[1,0]
  v_pk_fma_f32 v[18:19], v[16:17], v[16:17], v[58:59] op_sel_hi:[0,1,1] neg_lo:[0,0,1]
  v_cvt_pk_f16_f32 v50, v22, v23
  ds_write_b32 v1, v50 offset:28832
  v_cvt_pk_f16_f32 v51, v24, v25
  ds_write_b32 v1, v51 offset:29376
  v_cvt_pk_f16_f32 v48, v26, v27
  ds_write_b32 v1, v48 offset:29920
  v_cvt_pk_f16_f32 v49, v18, v19
  ds_write_b32 v1, v49 offset:30464
  v_pk_mul_f32 v[52:53], v[34:35], v[28:29] op_sel:[1,1] op_sel_hi:[1,0]
  v_pk_fma_f32 v[36:37], v[34:35], v[28:29], v[52:53] op_sel_hi:[0,1,1] neg_lo:[0,0,1]
  v_cvt_pk_f16_f32 v50, v34, -v35
  ds_write_b32 v1, v50 offset:13056
  v_pk_mul_f32 v[54:55], v[34:35], v[32:33] op_sel:[1,1] op_sel_hi:[1,0]
  v_pk_fma_f32 v[40:41], v[34:35], v[32:33], v[54:55] op_sel_hi:[0,1,1] neg_lo:[0,0,1]
  v_cvt_pk_f16_f32 v51, v40, -v41
  ds_write_b32 v1, v51 offset:13600
  v_pk_mul_f32 v[56:57], v[18:19], v[12:13] op_sel:[1,1] op_sel_hi:[1,0]
  v_pk_fma_f32 v[42:43], v[18:19], v[12:13], v[56:57] op_sel_hi:[0,1,1] neg_lo:[0,0,1]
  v_cvt_pk_f16_f32 v48, v42, v43
  ds_write_b32 v1, v48 offset:31008
  v_pk_mul_f32 v[58:59], v[36:37], v[28:29] op_sel:[1,1] op_sel_hi:[1,0]
  v_pk_fma_f32 v[34:35], v[36:37], v[28:29], v[58:59] op_sel_hi:[0,1,1] neg_lo:[0,0,1]
  v_cvt_pk_f16_f32 v49, v36, -v37
  ds_write_b32 v1, v49 offset:14144
  v_pk_mul_f32 v[52:53], v[36:37], v[32:33] op_sel:[1,1] op_sel_hi:[1,0]
  v_pk_fma_f32 v[40:41], v[36:37], v[32:33], v[52:53] op_sel_hi:[0,1,1] neg_lo:[0,0,1]
  v_cvt_pk_f16_f32 v50, v40, -v41
  ds_write_b32 v1, v50 offset:14688
  v_pk_mul_f32 v[54:55], v[18:19], v[14:15] op_sel:[1,1] op_sel_hi:[1,0]
  v_pk_fma_f32 v[42:43], v[18:19], v[14:15], v[54:55] op_sel_hi:[0,1,1] neg_lo:[0,0,1]
  v_cvt_pk_f16_f32 v51, v42, v43
  ds_write_b32 v1, v51 offset:31552
  v_pk_mul_f32 v[56:57], v[34:35], v[28:29] op_sel:[1,1] op_sel_hi:[1,0]
  v_pk_fma_f32 v[36:37], v[34:35], v[28:29], v[56:57] op_sel_hi:[0,1,1] neg_lo:[0,0,1]
  v_cvt_pk_f16_f32 v48, v34, -v35
  ds_write_b32 v1, v48 offset:15232
  v_pk_mul_f32 v[58:59], v[34:35], v[32:33] op_sel:[1,1] op_sel_hi:[1,0]
  v_pk_fma_f32 v[40:41], v[34:35], v[32:33], v[58:59] op_sel_hi:[0,1,1] neg_lo:[0,0,1]
  v_cvt_pk_f16_f32 v49, v40, -v41
  ds_write_b32 v1, v49 offset:15776
  v_pk_mul_f32 v[52:53], v[18:19], v[20:21] op_sel:[1,1] op_sel_hi:[1,0]
  v_pk_fma_f32 v[42:43], v[18:19], v[20:21], v[52:53] op_sel_hi:[0,1,1] neg_lo:[0,0,1]
  v_cvt_pk_f16_f32 v50, v42, v43
  ds_write_b32 v1, v50 offset:32096
  v_pk_mul_f32 v[54:55], v[36:37], v[28:29] op_sel:[1,1] op_sel_hi:[1,0]
  v_pk_fma_f32 v[34:35], v[36:37], v[28:29], v[54:55] op_sel_hi:[0,1,1] neg_lo:[0,0,1]
  v_cvt_pk_f16_f32 v51, v36, -v37
  ds_write_b32 v1, v51 offset:16320
  v_pk_mul_f32 v[56:57], v[36:37], v[32:33] op_sel:[1,1] op_sel_hi:[1,0]
  v_pk_fma_f32 v[40:41], v[36:37], v[32:33], v[56:57] op_sel_hi:[0,1,1] neg_lo:[0,0,1]
  v_cvt_pk_f16_f32 v48, v40, -v41
  ds_write_b32 v1, v48 offset:16864
  v_pk_mul_f32 v[58:59], v[18:19], v[16:17] op_sel:[1,1] op_sel_hi:[1,0]
  v_pk_fma_f32 v[42:43], v[18:19], v[16:17], v[58:59] op_sel_hi:[0,1,1] neg_lo:[0,0,1]
  v_cvt_pk_f16_f32 v49, v42, v43
  ds_write_b32 v1, v49 offset:32640
  v_pk_mul_f32 v[52:53], v[34:35], v[28:29] op_sel:[1,1] op_sel_hi:[1,0]
  v_pk_fma_f32 v[36:37], v[34:35], v[28:29], v[52:53] op_sel_hi:[0,1,1] neg_lo:[0,0,1]
  v_cvt_pk_f16_f32 v50, v34, -v35
  ds_write_b32 v1, v50 offset:17408
  v_cvt_pk_f16_f32 v51, -v34, v35
  ds_write_b32 v1, v51 offset:23392
  v_pk_mul_f32 v[54:55], v[18:19], v[22:23] op_sel:[1,1] op_sel_hi:[1,0]
  v_pk_fma_f32 v[42:43], v[18:19], v[22:23], v[54:55] op_sel_hi:[0,1,1] neg_lo:[0,0,1]
  v_cvt_pk_f16_f32 v48, v42, v43
  ds_write_b32 v1, v48 offset:33184
  v_pk_mul_f32 v[56:57], v[36:37], v[28:29] op_sel:[1,1] op_sel_hi:[1,0]
  v_pk_fma_f32 v[34:35], v[36:37], v[28:29], v[56:57] op_sel_hi:[0,1,1] neg_lo:[0,0,1]
  v_cvt_pk_f16_f32 v49, v36, -v37
  ds_write_b32 v1, v49 offset:17952
  v_pk_mul_f32 v[58:59], v[18:19], v[24:25] op_sel:[1,1] op_sel_hi:[1,0]
  v_pk_fma_f32 v[42:43], v[18:19], v[24:25], v[58:59] op_sel_hi:[0,1,1] neg_lo:[0,0,1]
  v_cvt_pk_f16_f32 v50, v42, v43
  ds_write_b32 v1, v50 offset:33728
  v_pk_mul_f32 v[52:53], v[34:35], v[28:29] op_sel:[1,1] op_sel_hi:[1,0]
  v_pk_fma_f32 v[36:37], v[34:35], v[28:29], v[52:53] op_sel_hi:[0,1,1] neg_lo:[0,0,1]
  v_cvt_pk_f16_f32 v51, v34, -v35
  ds_write_b32 v1, v51 offset:18496
  v_pk_mul_f32 v[54:55], v[18:19], v[26:27] op_sel:[1,1] op_sel_hi:[1,0]
  v_pk_fma_f32 v[42:43], v[18:19], v[26:27], v[54:55] op_sel_hi:[0,1,1] neg_lo:[0,0,1]
  v_cvt_pk_f16_f32 v48, v42, v43
  ds_write_b32 v1, v48 offset:34272
  v_pk_mul_f32 v[56:57], v[36:37], v[28:29] op_sel:[1,1] op_sel_hi:[1,0]
  v_pk_fma_f32 v[34:35], v[36:37], v[28:29], v[56:57] op_sel_hi:[0,1,1] neg_lo:[0,0,1]
  v_cvt_pk_f16_f32 v49, v36, -v37
  ds_write_b32 v1, v49 offset:19040
  v_pk_mul_f32 v[58:59], v[34:35], v[28:29] op_sel:[1,1] op_sel_hi:[1,0]
  v_pk_fma_f32 v[36:37], v[34:35], v[28:29], v[58:59] op_sel_hi:[0,1,1] neg_lo:[0,0,1]
  v_cvt_pk_f16_f32 v50, v34, -v35
  ds_write_b32 v1, v50 offset:19584
  v_pk_mul_f32 v[52:53], v[36:37], v[28:29] op_sel:[1,1] op_sel_hi:[1,0]
  v_pk_fma_f32 v[34:35], v[36:37], v[28:29], v[52:53] op_sel_hi:[0,1,1] neg_lo:[0,0,1]
  v_cvt_pk_f16_f32 v51, v36, -v37
  ds_write_b32 v1, v51 offset:20128
  v_pk_mul_f32 v[54:55], v[34:35], v[28:29] op_sel:[1,1] op_sel_hi:[1,0]
  v_pk_fma_f32 v[36:37], v[34:35], v[28:29], v[54:55] op_sel_hi:[0,1,1] neg_lo:[0,0,1]
  v_cvt_pk_f16_f32 v48, v34, -v35
  ds_write_b32 v1, v48 offset:20672
  v_pk_mul_f32 v[56:57], v[36:37], v[28:29] op_sel:[1,1] op_sel_hi:[1,0]
  v_pk_fma_f32 v[34:35], v[36:37], v[28:29], v[56:57] op_sel_hi:[0,1,1] neg_lo:[0,0,1]
  v_cvt_pk_f16_f32 v49, v36, -v37
  ds_write_b32 v1, v49 offset:21216
  v_cvt_pk_f16_f32 v50, v34, -v35
  ds_write_b32 v1, v50 offset:21760
k12_kernel_tabdone:
  s_waitcnt lgkmcnt(0)
  s_barrier
  s_cmp_ge_u32 s3, 3
  s_cbranch_scc1 k12_kernel_w3a
  ds_read_b128 v[12:15], v120 offset:0
  ds_read_b128 v[16:19], v121 offset:26112
  ds_read_b128 v[20:23], v120 offset:64
  ds_read_b128 v[24:27], v121 offset:26176
  ds_read_b128 v[28:31], v120 offset:128
  ds_read_b128 v[32:35], v121 offset:26240
  ds_read_b128 v[36:39], v120 offset:192
  ds_read_b128 v[40:43], v121 offset:26304
  s_waitcnt lgkmcnt(6)
  v_mfma_f32_16x16x32_f16 v[44:47], v[12:15], v[16:19], 0
  ds_read_b128 v[12:15], v120 offset:256
  ds_read_b128 v[16:19], v121 offset:26368
  s_waitcnt lgkmcnt(6)
  v_mfma_f32_16x16x32_f16 v[44:47], v[20:23], v[24:27], v[44:47]
  ds_read_b128 v[20:23], v120 offset:320
  ds_read_b128 v[24:27], v121 offset:26432
  s_waitcnt lgkmcnt(6)
  v_mfma_f32_16x16x32_f16 v[44:47], v[28:31], v[32:35], v[44:47]
  ds_read_b128 v[28:31], v120 offset:384
  ds_read_b128 v[32:35], v121 offset:26496
  s_waitcnt lgkmcnt(6)
  v_mfma_f32_16x16x32_f16 v[44:47], v[36:39], v[40:43], v[44:47]
  ds_read_b128 v[36:39], v120 offset:448
  ds_read_b128 v[40:43], v121 offset:26560
  s_waitcnt lgkmcnt(6)
  v_mfma_f32_16x16x32_f16 v[44:47], v[12:15], v[16:19], v[44:47]
  s_waitcnt lgkmcnt(4)
  v_mfma_f32_16x16x32_f16 v[44:47], v[20:23], v[24:27], v[44:47]
  s_waitcnt lgkmcnt(2)
  v_mfma_f32_16x16x32_f16 v[44:47], v[28:31], v[32:35], v[44:47]
  s_waitcnt lgkmcnt(0)
  v_mfma_f32_16x16x32_f16 v[44:47], v[36:39], v[40:43], v[44:47]
  s_nop 7
  ds_write_b128 v122, v[44:47] offset:34816
  s_branch k12_kernel_nomfma
k12_kernel_w3a:
  global_load_dword v126, v127, s[36:37] sc1
k12_kernel_nomfma:
  v_pk_mov_b32 v[56:57], 0, 0
  v_pk_mov_b32 v[58:59], 0, 0
  s_waitcnt lgkmcnt(0)
  s_barrier
  ds_read_b32 v28, v68 offset:34816
  ds_read_b32 v29, v69 offset:34816
  ds_read_b32 v30, v70 offset:34816
  ds_read_b32 v31, v71 offset:34816
  ds_read_b32 v32, v72 offset:34816
  ds_read_b32 v33, v73 offset:34816
  ds_read_b32 v34, v74 offset:34816
  ds_read_b32 v35, v75 offset:34816
  s_cmp_ge_u32 s3, 3
  s_cbranch_scc1 k12_kernel_pads
  ds_read_b32 v36, v76 offset:34816
  ds_read_b32 v37, v77 offset:34816
  ds_read_b32 v38, v78 offset:34816
  ds_read_b32 v39, v79 offset:34816
  ds_read_b32 v40, v80 offset:34816
  ds_read_b32 v41, v81 offset:34816
  ds_read_b32 v42, v82 offset:34816
  ds_read_b32 v43, v83 offset:34816
  v_cmp_gt_u32 vcc, 152, v0
  s_waitcnt lgkmcnt(14)
  v_cvt_pk_f16_f32 v44, v28, v29
  s_waitcnt lgkmcnt(12)
  v_cvt_pk_f16_f32 v45, v30, v31
  s_waitcnt lgkmcnt(10)
  v_cvt_pk_f16_f32 v46, v32, v33
  s_waitcnt lgkmcnt(8)
  v_cvt_pk_f16_f32 v47, v34, v35
  ds_write_b128 v116, v[44:47] offset:0
  s_waitcnt lgkmcnt(7)
  v_cvt_pk_f16_f32 v48, v36, v37
  s_waitcnt lgkmcnt(5)
  v_cvt_pk_f16_f32 v49, v38, v39
  s_waitcnt lgkmcnt(3)
  v_cvt_pk_f16_f32 v50, v40, v41
  s_waitcnt lgkmcnt(1)
  v_cvt_pk_f16_f32 v51, v42, v43
  s_and_saveexec_b64 s[24:25], vcc
  ds_write_b128 v116, v[48:51] offset:4096
  s_mov_b64 exec, -1
  s_branch k12_kernel_img1
k12_kernel_pads:
  s_mov_b32 exec_hi, 0xf
  ds_write_b128 v117, v[56:59] offset:6656
  ds_write_b128 v117, v[56:59] offset:13840
  s_mov_b32 exec_hi, 0
  ds_write_b128 v117, v[56:59] offset:11328
  s_mov_b32 exec_lo, 0x1ffff
  ds_write_b128 v117, v[56:59] offset:16448
  ds_write_b128 v117, v[56:59] offset:20816
  ds_write_b128 v117, v[56:59] offset:25040
  s_mov_b64 exec, -1
  s_mov_b32 s21, 200000
  s_waitcnt vmcnt(0)
k12_kernel_poll0:
  v_cmp_eq_u32 vcc, 0, v126
  s_sub_u32 s21, s21, 1
  s_cmp_lt_i32 s21, 1
  s_cbranch_scc1 k12_kernel_poll1a
  s_cbranch_vccz k12_kernel_poll1a
  s_sleep 16
  global_load_dword v126, v127, s[36:37] sc1
  s_waitcnt vmcnt(0)
  s_branch k12_kernel_poll0
k12_kernel_poll1a:
  s_cmp_ge_u32 s2, 512
  s_cbranch_scc1 k12_kernel_nb1
  global_load_dword v126, v111, s[30:31] sc1
  s_branch k12_kernel_nb2
k12_kernel_nb1:
  global_load_dwordx2 v[124:125], v123, s[30:31] sc1
k12_kernel_nb2:
  s_waitcnt lgkmcnt(6)
  v_cvt_pk_f16_f32 v44, v28, v29
  v_cvt_pk_f16_f32 v45, v30, v31
  v_cvt_pk_f16_f32 v46, v32, v33
  v_cvt_pk_f16_f32 v47, v34, v35
  ds_write_b128 v116, v[44:47] offset:0
  s_cmp_ge_u32 s2, 512
  s_cbranch_scc1 k12_kernel_poll
k12_kernel_bpoll:
  s_sub_u32 s21, s21, 1
  s_waitcnt vmcnt(0)
  v_cmp_ne_u32 vcc, 1, v126
  s_cmp_lt_i32 s21, 1
  s_cbranch_scc1 k12_kernel_img1
  s_cbranch_vccz k12_kernel_bok
  s_sleep 2
  global_load_dword v126, v111, s[30:31] sc1
  s_branch k12_kernel_bpoll
k12_kernel_bok:
  global_load_dwordx2 v[124:125], v123, s[30:31] sc1
k12_kernel_poll:
  s_sub_u32 s21, s21, 1
  s_waitcnt vmcnt(0)
  v_and_b32 v124, v124, v125
  v_cmp_ne_u32 vcc, 1, v124
  s_cmp_lt_i32 s21, 1
  s_cbranch_scc1 k12_kernel_img1
  s_cbranch_vccz k12_kernel_img1
  s_sleep 2
  global_load_dwordx2 v[124:125], v123, s[30:31] sc1
  s_branch k12_kernel_poll
k12_kernel_img1:
  s_waitcnt lgkmcnt(0)
  s_barrier
  buffer_load_dwordx4 v[82:85], v118, s[8:11], 0 offen sc1
  s_mov_b32 exec_lo, 1
  s_brev_b32 exec_hi, 1
  buffer_load_dwordx2 v[80:81], v110, s[8:11], 0 offen sc1
  s_mov_b64 exec, -1
  s_cmp_ge_u32 s3, 2
  s_cbranch_scc1 k12_kernel_tBC
  ds_read_b64 v[4:5], v113 offset:512
  ds_read_b64 v[6:7], v113 offset:520
  ds_read_b64 v[8:9], v113 offset:448
  ds_read_b64 v[10:11], v113 offset:456
  ds_read_b64 v[12:13], v113 offset:384
  ds_read_b64 v[14:15], v113 offset:392
  ds_read_b64 v[16:17], v113 offset:320
  ds_read_b64 v[18:19], v113 offset:328
  ds_read_b64 v[20:21], v113 offset:256
  ds_read_b64 v[22:23], v113 offset:264
  ds_read_b64 v[24:25], v113 offset:192
  ds_read_b64 v[26:27], v113 offset:200
  ds_read_b64 v[28:29], v113 offset:128
  ds_read_b64 v[30:31], v113 offset:136
  ds_read_b64 v[32:33], v113 offset:64
  ds_read_b64 v[34:35], v113 offset:72
  ds_read_b64 v[36:37], v113 offset:0
  ds_read_b64 v[38:39], v113 offset:8
  ds_read_b64 v[40:41], v113 offset:608
  ds_read_b64 v[42:43], v113 offset:616
  s_branch k12_kernel_polled
k12_kernel_tBC:
  s_cmp_eq_u32 s3, 3
  s_cbranch_scc1 k12_kernel_tC
  ds_read_b64 v[4:5], v113 offset:5760
  ds_read_b64 v[6:7], v113 offset:5768
  ds_read_b64 v[8:9], v113 offset:5792
  ds_read_b64 v[10:11], v113 offset:5800
  ds_read_b64 v[12:13], v113 offset:5824
  ds_read_b64 v[14:15], v113 offset:5832
  ds_read_b64 v[16:17], v113 offset:5856
  ds_read_b64 v[18:19], v113 offset:5864
  ds_read_b64 v[20:21], v113 offset:5888
  ds_read_b64 v[22:23], v113 offset:5896
  ds_read_b64 v[24:25], v113 offset:5920
  ds_read_b64 v[26:27], v113 offset:5928
  ds_read_b64 v[28:29], v113 offset:5952
  ds_read_b64 v[30:31], v113 offset:5960
  ds_read_b64 v[32:33], v113 offset:5984
  ds_read_b64 v[34:35], v113 offset:5992
  s_branch k12_kernel_polled
k12_kernel_tC:
  ds_read_b64 v[4:5], v113 offset:4608
  ds_read_b64 v[6:7], v113 offset:4616
  ds_read_b64 v[8:9], v113 offset:4640
  ds_read_b64 v[10:11], v113 offset:4648
  ds_read_b64 v[12:13], v113 offset:4672
  ds_read_b64 v[14:15], v113 offset:4680
  ds_read_b64 v[16:17], v113 offset:4704
  ds_read_b64 v[18:19], v113 offset:4712
  ds_read_b64 v[20:21], v113 offset:4736
  ds_read_b64 v[22:23], v113 offset:4744
  ds_read_b64 v[24:25], v113 offset:4768
  ds_read_b64 v[26:27], v113 offset:4776
  ds_read_b64 v[28:29], v114 offset:2816
  ds_read_b64 v[30:31], v114 offset:2824
  ds_read_b64 v[32:33], v114 offset:2848
  ds_read_b64 v[34:35], v114 offset:2856
  ds_read_b64 v[36:37], v114 offset:2880
  ds_read_b64 v[38:39], v114 offset:2888
  ds_read_b64 v[40:41], v114 offset:2912
  ds_read_b64 v[42:43], v114 offset:2920
  ds_read_b64 v[44:45], v114 offset:2944
  ds_read_b64 v[46:47], v114 offset:2952
k12_kernel_polled:
  s_waitcnt vmcnt(1)
  ds_write_b128 v116, v[82:85] offset:7232
  v_alignbit_b32 v90, v83, v82, 16
  v_alignbit_b32 v91, v84, v83, 16
  v_alignbit_b32 v92, v85, v84, 16
  v_pk_mov_b32 v[58:59], v[82:83], v[84:85] op_sel:[1,0]
  s_waitcnt vmcnt(0)
  v_mov_b32 v86, v80
  v_mov_b32 v87, v81
  v_mov_b32 v80, v84 wave_shr:1
  v_mov_b32 v81, v85 wave_shr:1
  v_mov_b32 v86, v82 wave_shl:1
  v_mov_b32 v87, v83 wave_shl:1
  v_alignbit_b32 v89, v82, v81, 16
  v_alignbit_b32 v93, v86, v85, 16
  v_alignbit_b32 v88, v81, v80, 16
  v_alignbit_b32 v94, v87, v86, 16
  v_pk_mov_b32 v[56:57], v[80:81], v[82:83] op_sel:[1,0]
  ds_write_b128 v116, v[56:59] offset:25312
  v_pk_add_f16 v96, v89, v82
  v_pk_add_f16 v97, v90, v83
  v_pk_add_f16 v98, v91, v84
  v_pk_add_f16 v99, v92, v85
  v_pk_add_f16 v96, v96, v90
  v_pk_add_f16 v97, v97, v91
  v_pk_add_f16 v98, v98, v92
  v_pk_add_f16 v99, v99, v93
  ds_write_b128 v116, v[96:99] offset:21088
  v_pk_add_f16 v100, v96, v81
  v_pk_add_f16 v101, v97, v82
  v_pk_add_f16 v102, v98, v83
  v_pk_add_f16 v103, v99, v84
  v_pk_add_f16 v100, v100, v83
  v_pk_add_f16 v101, v101, v84
  v_pk_add_f16 v102, v102, v85
  v_pk_add_f16 v103, v103, v86
  ds_write_b128 v116, v[100:103] offset:16720
  s_cmp_ge_u32 s3, 2
  s_cbranch_scc1 k12_kernel_prepdone
  v_pk_add_f16 v104, v100, v88
  v_pk_add_f16 v105, v101, v89
  v_pk_add_f16 v106, v102, v90
  v_pk_add_f16 v107, v103, v91
  v_pk_add_f16 v104, v104, v91
  v_pk_add_f16 v105, v105, v92
  v_pk_add_f16 v106, v106, v93
  v_pk_add_f16 v107, v107, v94
  ds_write_b128 v116, v[104:107] offset:14416
  v_pk_add_f16 v108, v104, v80
  v_pk_add_f16 v109, v105, v81
  v_pk_add_f16 v110, v106, v82
  v_pk_add_f16 v111, v107, v83
  v_pk_add_f16 v108, v108, v84
  v_pk_add_f16 v109, v109, v85
  v_pk_add_f16 v110, v110, v86
  v_pk_add_f16 v111, v111, v87
  ds_write_b128 v116, v[108:111] offset:11840
  s_cmp_lg_u32 s3, 0
  s_cbranch_scc1 k12_kernel_prepdone
  v_pack_b32_f16 v48, v82, v96
  v_pack_b32_f16 v49, v100, v104
  v_lshlrev_b32 v50, 16, v82
  v_pack_b32_f16 v51, v96, v100
  s_mov_b64 exec, 1
  ds_write_b64 v116, v[48:49] offset:11832
  ds_write_b64 v116, v[50:51] offset:14408
  ds_write_b32 v116, v48 offset:16716
  ds_write_b32 v116, v50 offset:21084
  s_mov_b64 exec, -1
k12_kernel_prepdone:
  s_waitcnt lgkmcnt(0)
  s_barrier
  s_cmp_lt_u32 s2, 512
  s_cbranch_scc1 k12_kernel_cpf4
  s_and_b32 s42, s2, 7
  s_sub_u32 s43, s2, 512
  s_lshr_b32 s43, s43, 3
  s_lshl_b32 s43, s43, 8
  v_add_u32 v123, s43, v0
  s_mov_b32 s44, s40
  s_mov_b32 s45, s41
  s_mov_b32 s46, 7077888
  s_mov_b32 s47, 0x00020000
  s_lshr_b32 s48, s42, 1
  s_mul_i32 s48, s48, 896
  s_and_b32 s49, s42, 1
  s_mul_i32 s49, s49, 3538944
  s_add_u32 s48, s48, s49
  s_add_u32 s46, s49, 3538944
  v_lshrrev_b32 v124, 3, v123
  v_mul_u32_u24 v124, 3456, v124
  v_and_b32 v125, 7, v123
  v_lshl_add_u32 v124, v125, 7, v124
  v_add_u32 v124, s48, v124
  s_mov_b32 s49, 0
  buffer_load_dword v126, v124, s[44:47], s49 offen
k12_kernel_cpf4:
  s_cmp_ge_u32 s3, 2
  s_cbranch_scc1 k12_kernel_rBC
  s_cmp_eq_u32 s3, 1
  s_cbranch_scc1 k12_kernel_rA2
  ds_read_b128 v[80:83], v112 offset:64
  ds_read_b128 v[84:87], v112 offset:128
  ds_read_b128 v[88:91], v112 offset:192
  ds_read_b128 v[92:95], v112 offset:256
  ds_read_b128 v[96:99], v112 offset:320
  ds_read_b128 v[100:103], v112 offset:384
  s_waitcnt lgkmcnt(4)
  v_mfma_f32_16x16x32_f16 v[48:51], v[32:35], v[80:83], 0
  ds_read_b128 v[104:107], v112 offset:448
  v_mfma_f32_16x16x32_f16 v[48:51], v[28:31], v[84:87], v[48:51]
  ds_read_b128 v[108:111], v112 offset:512
  s_waitcnt lgkmcnt(4)
  v_mfma_f32_16x16x32_f16 v[48:51], v[24:27], v[88:91], v[48:51]
  ds_read_b128 v[80:83], v112 offset:576
  v_mfma_f32_16x16x32_f16 v[48:51], v[20:23], v[92:95], v[48:51]
  ds_read_b128 v[84:87], v112 offset:640
  s_waitcnt lgkmcnt(4)
  v_mfma_f32_16x16x32_f16 v[48:51], v[16:19], v[96:99], v[48:51]
  ds_read_b128 v[88:91], v112 offset:704
  v_mfma_f32_16x16x32_f16 v[48:51], v[12:15], v[100:103], v[48:51]
  ds_read_b128 v[92:95], v112 offset:768
  s_waitcnt lgkmcnt(4)
  v_mfma_f32_16x16x32_f16 v[48:51], v[8:11], v[104:107], v[48:51]
  ds_read_b128 v[96:99], v112 offset:832
  v_mfma_f32_16x16x32_f16 v[48:51], v[4:7], v[108:111], v[48:51]
  v_mfma_f32_16x16x32_f16 v[52:55], v[36:39], v[108:111], 0
  ds_read_b128 v[100:103], v112 offset:896
  s_waitcnt lgkmcnt(4)
  v_mfma_f32_16x16x32_f16 v[52:55], v[32:35], v[80:83], v[52:55]
  ds_read_b128 v[104:107], v112 offset:960
  v_mfma_f32_16x16x32_f16 v[52:55], v[28:31], v[84:87], v[52:55]
  ds_read_b128 v[108:111], v112 offset:1024
  s_waitcnt lgkmcnt(4)
  v_mfma_f32_16x16x32_f16 v[52:55], v[24:27], v[88:91], v[52:55]
  ds_read_b128 v[80:83], v112 offset:1088
  v_mfma_f32_16x16x32_f16 v[52:55], v[20:23], v[92:95], v[52:55]
  ds_read_b128 v[84:87], v112 offset:1152
  s_waitcnt lgkmcnt(4)
  v_mfma_f32_16x16x32_f16 v[52:55], v[16:19], v[96:99], v[52:55]
  ds_read_b128 v[88:91], v112 offset:1216
  v_mfma_f32_16x16x32_f16 v[52:55], v[12:15], v[100:103], v[52:55]
  ds_read_b128 v[92:95], v112 offset:1280
  s_waitcnt lgkmcnt(4)
  v_mfma_f32_16x16x32_f16 v[52:55], v[8:11], v[104:107], v[52:55]
  ds_read_b128 v[96:99], v112 offset:1344
  v_mfma_f32_16x16x32_f16 v[52:55], v[4:7], v[108:111], v[52:55]
  v_mfma_f32_16x16x32_f16 v[56:59], v[36:39], v[108:111], 0
  ds_read_b128 v[100:103], v112 offset:1408
  s_waitcnt lgkmcnt(4)
  v_mfma_f32_16x16x32_f16 v[56:59], v[32:35], v[80:83], v[56:59]
  ds_read_b128 v[104:107], v112 offset:1472
  v_mfma_f32_16x16x32_f16 v[56:59], v[28:31], v[84:87], v[56:59]
  ds_read_b128 v[108:111], v112 offset:1536
  s_waitcnt lgkmcnt(4)
  v_mfma_f32_16x16x32_f16 v[56:59], v[24:27], v[88:91], v[56:59]
  ds_read_b128 v[80:83], v112 offset:1600
  v_mfma_f32_16x16x32_f16 v[56:59], v[20:23], v[92:95], v[56:59]
  ds_read_b128 v[84:87], v112 offset:1664
  s_waitcnt lgkmcnt(4)
  v_mfma_f32_16x16x32_f16 v[56:59], v[16:19], v[96:99], v[56:59]
  ds_read_b128 v[88:91], v112 offset:1728
  v_mfma_f32_16x16x32_f16 v[56:59], v[12:15], v[100:103], v[56:59]
  ds_read_b128 v[92:95], v112 offset:1792
  s_waitcnt lgkmcnt(4)
  v_mfma_f32_16x16x32_f16 v[56:59], v[8:11], v[104:107], v[56:59]
  ds_read_b128 v[96:99], v112 offset:1856
  v_mfma_f32_16x16x32_f16 v[56:59], v[4:7], v[108:111], v[56:59]
  v_mfma_f32_16x16x32_f16 v[60:63], v[36:39], v[108:111], 0
  ds_read_b128 v[100:103], v112 offset:1920
  s_waitcnt lgkmcnt(4)
  v_mfma_f32_16x16x32_f16 v[60:63], v[32:35], v[80:83], v[60:63]
  ds_read_b128 v[104:107], v112 offset:1984
  v_mfma_f32_16x16x32_f16 v[60:63], v[28:31], v[84:87], v[60:63]
  ds_read_b128 v[108:111], v112 offset:2048
  s_waitcnt lgkmcnt(4)
  v_mfma_f32_16x16x32_f16 v[60:63], v[24:27], v[88:91], v[60:63]
  ds_read_b128 v[80:83], v112 offset:32
  v_mfma_f32_16x16x32_f16 v[60:63], v[20:23], v[92:95], v[60:63]
  s_waitcnt lgkmcnt(3)
  v_mfma_f32_16x16x32_f16 v[60:63], v[16:19], v[96:99], v[60:63]
  v_mfma_f32_16x16x32_f16 v[60:63], v[12:15], v[100:103], v[60:63]
  s_waitcnt lgkmcnt(1)
  v_mfma_f32_16x16x32_f16 v[60:63], v[8:11], v[104:107], v[60:63]
  v_mfma_f32_16x16x32_f16 v[60:63], v[4:7], v[108:111], v[60:63]
  s_waitcnt lgkmcnt(0)
  v_mfma_f32_16x16x32_f16 v[60:63], v[40:43], v[80:83], v[60:63]
  v_mov_b32 v2, s27
  s_waitcnt lgkmcnt(0)
  s_barrier
  ds_read_b128 v[80:83], v117 offset:0
  ds_read_b128 v[88:91], v117 offset:1024
  ds_read_b128 v[92:95], v117 offset:31456
  ds_read_b128 v[96:99], v117 offset:2048
  ds_read_b128 v[100:103], v117 offset:32480
  ds_read_b128 v[104:107], v117 offset:3072
  ds_read_b128 v[108:111], v117 offset:33504
  s_waitcnt lgkmcnt(6)
  v_pk_add_f32 v[48:49], v[48:49], v[80:81]
  v_pk_add_f32 v[50:51], v[50:51], v[82:83]
  v_pk_mul_f32 v[48:49], v[48:49], v[2:3] op_sel_hi:[1,0]
  v_pk_mul_f32 v[50:51], v[50:51], v[2:3] op_sel_hi:[1,0]
  v_cvt_pk_bf16_f32 v4, v48, v49
  v_cvt_pk_bf16_f32 v5, v50, v51
  s_waitcnt lgkmcnt(4)
  v_pk_add_f32 v[52:53], v[52:53], v[88:89]
  v_pk_add_f32 v[54:55], v[54:55], v[90:91]
  v_pk_add_f32 v[52:53], v[52:53], v[92:93]
  v_pk_add_f32 v[54:55], v[54:55], v[94:95]
  v_pk_mul_f32 v[52:53], v[52:53], v[2:3] op_sel_hi:[1,0]
  v_pk_mul_f32 v[54:55], v[54:55], v[2:3] op_sel_hi:[1,0]
  v_cvt_pk_bf16_f32 v6, v52, v53
  v_cvt_pk_bf16_f32 v7, v54, v55
  s_mov_b32 s20, 0
  s_nop 0
  v_permlane16_swap_b32 v4, v6
  v_permlane16_swap_b32 v5, v7
  buffer_store_dwordx4 v[4:7], v119, s[32:35], s20 offen
  s_waitcnt lgkmcnt(2)
  v_pk_add_f32 v[56:57], v[56:57], v[96:97]
  v_pk_add_f32 v[58:59], v[58:59], v[98:99]
  v_pk_add_f32 v[56:57], v[56:57], v[100:101]
  v_pk_add_f32 v[58:59], v[58:59], v[102:103]
  v_pk_mul_f32 v[56:57], v[56:57], v[2:3] op_sel_hi:[1,0]
  v_pk_mul_f32 v[58:59], v[58:59], v[2:3] op_sel_hi:[1,0]
  v_cvt_pk_bf16_f32 v8, v56, v57
  v_cvt_pk_bf16_f32 v9, v58, v59
  s_waitcnt lgkmcnt(0)
  v_pk_add_f32 v[60:61], v[60:61], v[104:105]
  v_pk_add_f32 v[62:63], v[62:63], v[106:107]
  v_pk_add_f32 v[60:61], v[60:61], v[108:109]
  v_pk_add_f32 v[62:63], v[62:63], v[110:111]
  v_pk_mul_f32 v[60:61], v[60:61], v[2:3] op_sel_hi:[1,0]
  v_pk_mul_f32 v[62:63], v[62:63], v[2:3] op_sel_hi:[1,0]
  v_cvt_pk_bf16_f32 v10, v60, v61
  v_cvt_pk_bf16_f32 v11, v62, v63
  s_mov_b32 s20, 659456
  s_nop 0
  v_permlane16_swap_b32 v8, v10
  v_permlane16_swap_b32 v9, v11
  buffer_store_dwordx4 v[8:11], v119, s[32:35], s20 offen
  s_branch k12_kernel_fin
k12_kernel_rA2:
  ds_read_b128 v[80:83], v112 offset:2048
  ds_read_b128 v[84:87], v112 offset:2112
  ds_read_b128 v[88:91], v112 offset:2176
  ds_read_b128 v[92:95], v112 offset:2240
  ds_read_b128 v[96:99], v112 offset:2304
  ds_read_b128 v[100:103], v112 offset:2368
  s_waitcnt lgkmcnt(4)
  v_mfma_f32_16x16x32_f16 v[48:51], v[36:39], v[80:83], 0
  ds_read_b128 v[104:107], v112 offset:2432
  v_mfma_f32_16x16x32_f16 v[48:51], v[32:35], v[84:87], v[48:51]
  ds_read_b128 v[108:111], v112 offset:2496
  s_waitcnt lgkmcnt(4)
  v_mfma_f32_16x16x32_f16 v[48:51], v[28:31], v[88:91], v[48:51]
  ds_read_b128 v[80:83], v112 offset:2560
  v_mfma_f32_16x16x32_f16 v[48:51], v[24:27], v[92:95], v[48:51]
  ds_read_b128 v[84:87], v112 offset:2624
  s_waitcnt lgkmcnt(4)
  v_mfma_f32_16x16x32_f16 v[48:51], v[20:23], v[96:99], v[48:51]
  ds_read_b128 v[88:91], v112 offset:2688
  v_mfma_f32_16x16x32_f16 v[48:51], v[16:19], v[100:103], v[48:51]
  ds_read_b128 v[92:95], v112 offset:2752
  s_waitcnt lgkmcnt(4)
  v_mfma_f32_16x16x32_f16 v[48:51], v[12:15], v[104:107], v[48:51]
  ds_read_b128 v[96:99], v112 offset:2816
  v_mfma_f32_16x16x32_f16 v[48:51], v[8:11], v[108:111], v[48:51]
  ds_read_b128 v[100:103], v112 offset:2880
  s_waitcnt lgkmcnt(4)
  v_mfma_f32_16x16x32_f16 v[48:51], v[4:7], v[80:83], v[48:51]
  v_mfma_f32_16x16x32_f16 v[52:55], v[36:39], v[80:83], 0
  ds_read_b128 v[104:107], v112 offset:2944
  v_mfma_f32_16x16x32_f16 v[52:55], v[32:35], v[84:87], v[52:55]
  ds_read_b128 v[108:111], v112 offset:3008
  s_waitcnt lgkmcnt(4)
  v_mfma_f32_16x16x32_f16 v[52:55], v[28:31], v[88:91], v[52:55]
  ds_read_b128 v[80:83], v112 offset:3072
  v_mfma_f32_16x16x32_f16 v[52:55], v[24:27], v[92:95], v[52:55]
  ds_read_b128 v[84:87], v112 offset:3136
  s_waitcnt lgkmcnt(4)
  v_mfma_f32_16x16x32_f16 v[52:55], v[20:23], v[96:99], v[52:55]
  ds_read_b128 v[88:91], v112 offset:3200
  v_mfma_f32_16x16x32_f16 v[52:55], v[16:19], v[100:103], v[52:55]
  ds_read_b128 v[92:95], v112 offset:3264
  s_waitcnt lgkmcnt(4)
  v_mfma_f32_16x16x32_f16 v[52:55], v[12:15], v[104:107], v[52:55]
  ds_read_b128 v[96:99], v112 offset:3328
  v_mfma_f32_16x16x32_f16 v[52:55], v[8:11], v[108:111], v[52:55]
  ds_read_b128 v[100:103], v112 offset:3392
  s_waitcnt lgkmcnt(4)
  v_mfma_f32_16x16x32_f16 v[52:55], v[4:7], v[80:83], v[52:55]
  v_mfma_f32_16x16x32_f16 v[56:59], v[36:39], v[80:83], 0
  ds_read_b128 v[104:107], v112 offset:3456
  v_mfma_f32_16x16x32_f16 v[56:59], v[32:35], v[84:87], v[56:59]
  ds_read_b128 v[108:111], v112 offset:3520
  s_waitcnt lgkmcnt(4)
  v_mfma_f32_16x16x32_f16 v[56:59], v[28:31], v[88:91], v[56:59]
  ds_read_b128 v[80:83], v112 offset:3584
  v_mfma_f32_16x16x32_f16 v[56:59], v[24:27], v[92:95], v[56:59]
  ds_read_b128 v[84:87], v112 offset:3648
  s_waitcnt lgkmcnt(4)
  v_mfma_f32_16x16x32_f16 v[56:59], v[20:23], v[96:99], v[56:59]
  ds_read_b128 v[88:91], v112 offset:3712
  v_mfma_f32_16x16x32_f16 v[56:59], v[16:19], v[100:103], v[56:59]
  ds_read_b128 v[92:95], v112 offset:3776
  s_waitcnt lgkmcnt(4)
  v_mfma_f32_16x16x32_f16 v[56:59], v[12:15], v[104:107], v[56:59]
  ds_read_b128 v[96:99], v112 offset:3840
  v_mfma_f32_16x16x32_f16 v[56:59], v[8:11], v[108:111], v[56:59]
  ds_read_b128 v[100:103], v112 offset:3904
  s_waitcnt lgkmcnt(4)
  v_mfma_f32_16x16x32_f16 v[56:59], v[4:7], v[80:83], v[56:59]
  v_mfma_f32_16x16x32_f16 v[60:63], v[36:39], v[80:83], 0
  ds_read_b128 v[104:107], v112 offset:3968
  v_mfma_f32_16x16x32_f16 v[60:63], v[32:35], v[84:87], v[60:63]
  ds_read_b128 v[108:111], v112 offset:4032
  s_waitcnt lgkmcnt(4)
  v_mfma_f32_16x16x32_f16 v[60:63], v[28:31], v[88:91], v[60:63]
  ds_read_b128 v[80:83], v112 offset:4096
  v_mfma_f32_16x16x32_f16 v[60:63], v[24:27], v[92:95], v[60:63]
  ds_read_b128 v[84:87], v112 offset:544
  s_waitcnt lgkmcnt(4)
  v_mfma_f32_16x16x32_f16 v[60:63], v[20:23], v[96:99], v[60:63]
  ds_read_b128 v[88:91], v112 offset:1056
  v_mfma_f32_16x16x32_f16 v[60:63], v[16:19], v[100:103], v[60:63]
  ds_read_b128 v[92:95], v112 offset:1568
  s_waitcnt lgkmcnt(4)
  v_mfma_f32_16x16x32_f16 v[60:63], v[12:15], v[104:107], v[60:63]
  ds_read_b128 v[96:99], v112 offset:2080
  v_mfma_f32_16x16x32_f16 v[60:63], v[8:11], v[108:111], v[60:63]
  s_waitcnt lgkmcnt(3)
  v_mfma_f32_16x16x32_f16 v[60:63], v[4:7], v[80:83], v[60:63]
  v_mfma_f32_16x16x32_f16 v[48:51], v[40:43], v[84:87], v[48:51]
  s_waitcnt lgkmcnt(1)
  v_mfma_f32_16x16x32_f16 v[52:55], v[40:43], v[88:91], v[52:55]
  v_mfma_f32_16x16x32_f16 v[56:59], v[40:43], v[92:95], v[56:59]
  s_waitcnt lgkmcnt(0)
  v_mfma_f32_16x16x32_f16 v[60:63], v[40:43], v[96:99], v[60:63]
  v_mov_b32 v2, s27
  s_waitcnt lgkmcnt(0)
  s_barrier
  ds_read_b128 v[80:83], v117 offset:4096
  ds_read_b128 v[84:87], v117 offset:34528
  ds_read_b128 v[88:91], v117 offset:5120
  ds_read_b128 v[92:95], v117 offset:35552
  ds_read_b128 v[96:99], v117 offset:29408
  ds_read_b128 v[100:103], v117 offset:36576
  ds_read_b128 v[104:107], v117 offset:30432
  ds_read_b128 v[108:111], v117 offset:37600
  s_waitcnt lgkmcnt(6)
  v_pk_add_f32 v[48:49], v[48:49], v[80:81]
  v_pk_add_f32 v[50:51], v[50:51], v[82:83]
  v_pk_add_f32 v[48:49], v[48:49], v[84:85]
  v_pk_add_f32 v[50:51], v[50:51], v[86:87]
  v_pk_mul_f32 v[48:49], v[48:49], v[2:3] op_sel_hi:[1,0]
  v_pk_mul_f32 v[50:51], v[50:51], v[2:3] op_sel_hi:[1,0]
  v_cvt_pk_bf16_f32 v4, v48, v49
  v_cvt_pk_bf16_f32 v5, v50, v51
  s_waitcnt lgkmcnt(4)
  v_pk_add_f32 v[52:53], v[52:53], v[88:89]
  v_pk_add_f32 v[54:55], v[54:55], v[90:91]
  v_pk_add_f32 v[52:53], v[52:53], v[92:93]
  v_pk_add_f32 v[54:55], v[54:55], v[94:95]
  v_pk_mul_f32 v[52:53], v[52:53], v[2:3] op_sel_hi:[1,0]
  v_pk_mul_f32 v[54:55], v[54:55], v[2:3] op_sel_hi:[1,0]
  v_cvt_pk_bf16_f32 v6, v52, v53
  v_cvt_pk_bf16_f32 v7, v54, v55
  s_mov_b32 s20, 1318912
  s_nop 0
  v_permlane16_swap_b32 v4, v6
  v_permlane16_swap_b32 v5, v7
  buffer_store_dwordx4 v[4:7], v119, s[32:35], s20 offen
  s_waitcnt lgkmcnt(2)
  v_pk_add_f32 v[56:57], v[56:57], v[96:97]
  v_pk_add_f32 v[58:59], v[58:59], v[98:99]
  v_pk_add_f32 v[56:57], v[56:57], v[100:101]
  v_pk_add_f32 v[58:59], v[58:59], v[102:103]
  v_pk_mul_f32 v[56:57], v[56:57], v[2:3] op_sel_hi:[1,0]
  v_pk_mul_f32 v[58:59], v[58:59], v[2:3] op_sel_hi:[1,0]
  v_cvt_pk_bf16_f32 v8, v56, v57
  v_cvt_pk_bf16_f32 v9, v58, v59
  s_waitcnt lgkmcnt(0)
  v_pk_add_f32 v[60:61], v[60:61], v[104:105]
  v_pk_add_f32 v[62:63], v[62:63], v[106:107]
  v_pk_add_f32 v[60:61], v[60:61], v[108:109]
  v_pk_add_f32 v[62:63], v[62:63], v[110:111]
  v_pk_mul_f32 v[60:61], v[60:61], v[2:3] op_sel_hi:[1,0]
  v_pk_mul_f32 v[62:63], v[62:63], v[2:3] op_sel_hi:[1,0]
  v_cvt_pk_bf16_f32 v10, v60, v61
  v_cvt_pk_bf16_f32 v11, v62, v63
  s_mov_b32 s20, 1978368
  s_nop 0
  v_permlane16_swap_b32 v8, v10
  v_permlane16_swap_b32 v9, v11
  buffer_store_dwordx4 v[8:11], v119, s[32:35], s20 offen
  s_branch k12_kernel_fin
k12_kernel_rBC:
  s_cmp_eq_u32 s3, 3
  s_cbranch_scc1 k12_kernel_rC
  ds_read_b64_tr_b16 v[80:81], v112 offset:0
  ds_read_b64_tr_b16 v[82:83], v112 offset:32
  ds_read_b64_tr_b16 v[84:85], v112 offset:128
  ds_read_b64_tr_b16 v[86:87], v112 offset:160
  ds_read_b64_tr_b16 v[88:89], v112 offset:256
  ds_read_b64_tr_b16 v[90:91], v112 offset:288
  ds_read_b64_tr_b16 v[92:93], v112 offset:384
  ds_read_b64_tr_b16 v[94:95], v112 offset:416
  ds_read_b64_tr_b16 v[96:97], v112 offset:512
  ds_read_b64_tr_b16 v[98:99], v112 offset:544
  ds_read_b64_tr_b16 v[100:101], v112 offset:640
  ds_read_b64_tr_b16 v[102:103], v112 offset:672
  s_waitcnt lgkmcnt(8)
  v_mfma_f32_16x16x32_f16 v[48:51], v[80:83], v[32:35], 0
  v_mfma_f32_16x16x32_f16 v[52:55], v[80:83], v[16:19], 0
  ds_read_b64_tr_b16 v[104:105], v112 offset:768
  ds_read_b64_tr_b16 v[106:107], v112 offset:800
  v_mfma_f32_16x16x32_f16 v[52:55], v[84:87], v[20:23], v[52:55]
  v_mfma_f32_16x16x32_f16 v[56:59], v[84:87], v[4:7], 0
  ds_read_b64_tr_b16 v[108:109], v112 offset:896
  ds_read_b64_tr_b16 v[110:111], v112 offset:928
  s_waitcnt lgkmcnt(8)
  v_mfma_f32_16x16x32_f16 v[52:55], v[88:91], v[24:27], v[52:55]
  v_mfma_f32_16x16x32_f16 v[56:59], v[88:91], v[8:11], v[56:59]
  ds_read_b64_tr_b16 v[80:81], v112 offset:1024
  ds_read_b64_tr_b16 v[82:83], v112 offset:1056
  v_mfma_f32_16x16x32_f16 v[52:55], v[92:95], v[28:31], v[52:55]
  v_mfma_f32_16x16x32_f16 v[56:59], v[92:95], v[12:15], v[56:59]
  ds_read_b64_tr_b16 v[84:85], v112 offset:1152
  ds_read_b64_tr_b16 v[86:87], v112 offset:1184
  s_waitcnt lgkmcnt(8)
  v_mfma_f32_16x16x32_f16 v[52:55], v[96:99], v[32:35], v[52:55]
  v_mfma_f32_16x16x32_f16 v[56:59], v[96:99], v[16:19], v[56:59]
  ds_read_b64_tr_b16 v[88:89], v112 offset:1280
  ds_read_b64_tr_b16 v[90:91], v112 offset:1312
  v_mfma_f32_16x16x32_f16 v[56:59], v[100:103], v[20:23], v[56:59]
  v_mfma_f32_16x16x32_f16 v[60:63], v[100:103], v[4:7], 0
  ds_read_b64_tr_b16 v[92:93], v112 offset:1408
  ds_read_b64_tr_b16 v[94:95], v112 offset:1440
  s_waitcnt lgkmcnt(8)
  v_mfma_f32_16x16x32_f16 v[56:59], v[104:107], v[24:27], v[56:59]
  v_mfma_f32_16x16x32_f16 v[60:63], v[104:107], v[8:11], v[60:63]
  ds_read_b64_tr_b16 v[96:97], v112 offset:1536
  ds_read_b64_tr_b16 v[98:99], v112 offset:1568
  v_mfma_f32_16x16x32_f16 v[56:59], v[108:111], v[28:31], v[56:59]
  v_mfma_f32_16x16x32_f16 v[60:63], v[108:111], v[12:15], v[60:63]
  ds_read_b64_tr_b16 v[100:101], v112 offset:1664
  ds_read_b64_tr_b16 v[102:103], v112 offset:1696
  s_waitcnt lgkmcnt(8)
  v_mfma_f32_16x16x32_f16 v[56:59], v[80:83], v[32:35], v[56:59]
  v_mfma_f32_16x16x32_f16 v[60:63], v[80:83], v[16:19], v[60:63]
  ds_read_b64_tr_b16 v[104:105], v112 offset:1792
  ds_read_b64_tr_b16 v[106:107], v112 offset:1824
  v_mfma_f32_16x16x32_f16 v[60:63], v[84:87], v[20:23], v[60:63]
  v_mfma_f32_16x16x32_f16 v[64:67], v[84:87], v[4:7], 0
  ds_read_b64_tr_b16 v[108:109], v112 offset:1920
  ds_read_b64_tr_b16 v[110:111], v112 offset:1952
  s_waitcnt lgkmcnt(8)
  v_mfma_f32_16x16x32_f16 v[60:63], v[88:91], v[24:27], v[60:63]
  v_mfma_f32_16x16x32_f16 v[64:67], v[88:91], v[8:11], v[64:67]
  ds_read_b64_tr_b16 v[80:81], v112 offset:2048
  ds_read_b64_tr_b16 v[82:83], v112 offset:2080
  v_mfma_f32_16x16x32_f16 v[60:63], v[92:95], v[28:31], v[60:63]
  v_mfma_f32_16x16x32_f16 v[64:67], v[92:95], v[12:15], v[64:67]
  ds_read_b64_tr_b16 v[84:85], v112 offset:2176
  ds_read_b64_tr_b16 v[86:87], v112 offset:2208
  s_waitcnt lgkmcnt(8)
  v_mfma_f32_16x16x32_f16 v[60:63], v[96:99], v[32:35], v[60:63]
  v_mfma_f32_16x16x32_f16 v[64:67], v[96:99], v[16:19], v[64:67]
  ds_read_b64_tr_b16 v[88:89], v112 offset:2304
  ds_read_b64_tr_b16 v[90:91], v112 offset:2336
  v_mfma_f32_16x16x32_f16 v[64:67], v[100:103], v[20:23], v[64:67]
  v_mfma_f32_16x16x32_f16 v[68:71], v[100:103], v[4:7], 0
  ds_read_b64_tr_b16 v[92:93], v112 offset:2432
  ds_read_b64_tr_b16 v[94:95], v112 offset:2464
  s_waitcnt lgkmcnt(8)
  v_mfma_f32_16x16x32_f16 v[64:67], v[104:107], v[24:27], v[64:67]
  v_mfma_f32_16x16x32_f16 v[68:71], v[104:107], v[8:11], v[68:71]
  ds_read_b64_tr_b16 v[96:97], v112 offset:2560
  ds_read_b64_tr_b16 v[98:99], v112 offset:2592
  v_mfma_f32_16x16x32_f16 v[64:67], v[108:111], v[28:31], v[64:67]
  v_mfma_f32_16x16x32_f16 v[68:71], v[108:111], v[12:15], v[68:71]
  ds_read_b64_tr_b16 v[100:101], v112 offset:2688
  ds_read_b64_tr_b16 v[102:103], v112 offset:2720
  s_waitcnt lgkmcnt(8)
  v_mfma_f32_16x16x32_f16 v[64:67], v[80:83], v[32:35], v[64:67]
  v_mfma_f32_16x16x32_f16 v[68:71], v[80:83], v[16:19], v[68:71]
  ds_read_b64_tr_b16 v[104:105], v112 offset:2816
  ds_read_b64_tr_b16 v[106:107], v112 offset:2848
  v_mfma_f32_16x16x32_f16 v[68:71], v[84:87], v[20:23], v[68:71]
  v_mfma_f32_16x16x32_f16 v[72:75], v[84:87], v[4:7], 0
  ds_read_b64_tr_b16 v[108:109], v112 offset:2944
  ds_read_b64_tr_b16 v[110:111], v112 offset:2976
  s_waitcnt lgkmcnt(8)
  v_mfma_f32_16x16x32_f16 v[68:71], v[88:91], v[24:27], v[68:71]
  v_mfma_f32_16x16x32_f16 v[72:75], v[88:91], v[8:11], v[72:75]
  ds_read_b64_tr_b16 v[80:81], v112 offset:3072
  ds_read_b64_tr_b16 v[82:83], v112 offset:3104
  v_mfma_f32_16x16x32_f16 v[68:71], v[92:95], v[28:31], v[68:71]
  v_mfma_f32_16x16x32_f16 v[72:75], v[92:95], v[12:15], v[72:75]
  ds_read_b64_tr_b16 v[84:85], v112 offset:3200
  ds_read_b64_tr_b16 v[86:87], v112 offset:3232
  s_waitcnt lgkmcnt(8)
  v_mfma_f32_16x16x32_f16 v[68:71], v[96:99], v[32:35], v[68:71]
  v_mfma_f32_16x16x32_f16 v[72:75], v[96:99], v[16:19], v[72:75]
  ds_read_b64_tr_b16 v[88:89], v112 offset:3328
  ds_read_b64_tr_b16 v[90:91], v112 offset:3360
  v_mfma_f32_16x16x32_f16 v[72:75], v[100:103], v[20:23], v[72:75]
  v_mfma_f32_16x16x32_f16 v[76:79], v[100:103], v[4:7], 0
  ds_read_b64_tr_b16 v[92:93], v112 offset:3456
  ds_read_b64_tr_b16 v[94:95], v112 offset:3488
  s_waitcnt lgkmcnt(8)
  v_mfma_f32_16x16x32_f16 v[72:75], v[104:107], v[24:27], v[72:75]
  v_mfma_f32_16x16x32_f16 v[76:79], v[104:107], v[8:11], v[76:79]
  ds_read_b64_tr_b16 v[96:97], v112 offset:3584
  ds_read_b64_tr_b16 v[98:99], v112 offset:3616
  v_mfma_f32_16x16x32_f16 v[72:75], v[108:111], v[28:31], v[72:75]
  v_mfma_f32_16x16x32_f16 v[76:79], v[108:111], v[12:15], v[76:79]
  s_waitcnt lgkmcnt(6)
  v_mfma_f32_16x16x32_f16 v[72:75], v[80:83], v[32:35], v[72:75]
  v_mfma_f32_16x16x32_f16 v[76:79], v[80:83], v[16:19], v[76:79]
  v_mfma_f32_16x16x32_f16 v[76:79], v[84:87], v[20:23], v[76:79]
  s_waitcnt lgkmcnt(2)
  v_mfma_f32_16x16x32_f16 v[76:79], v[88:91], v[24:27], v[76:79]
  v_mfma_f32_16x16x32_f16 v[76:79], v[92:95], v[28:31], v[76:79]
  s_waitcnt lgkmcnt(0)
  v_mfma_f32_16x16x32_f16 v[76:79], v[96:99], v[32:35], v[76:79]
  s_nop 1
  ds_write_b128 v117, v[48:51] offset:0
  ds_write_b128 v117, v[52:55] offset:1024
  ds_write_b128 v117, v[56:59] offset:2048
  ds_write_b128 v117, v[60:63] offset:3072
  ds_write_b128 v117, v[64:67] offset:4096
  ds_write_b128 v117, v[68:71] offset:5120
  ds_write_b128 v117, v[72:75] offset:29408
  ds_write_b128 v117, v[76:79] offset:30432
  s_waitcnt lgkmcnt(0)
  s_barrier
  s_branch k12_kernel_fin
k12_kernel_rC:
  ds_read_b64_tr_b16 v[80:81], v112 offset:0
  ds_read_b64_tr_b16 v[82:83], v112 offset:64
  ds_read_b64_tr_b16 v[84:85], v112 offset:256
  ds_read_b64_tr_b16 v[86:87], v112 offset:320
  ds_read_b64_tr_b16 v[88:89], v112 offset:512
  ds_read_b64_tr_b16 v[90:91], v112 offset:576
  ds_read_b64_tr_b16 v[92:93], v112 offset:768
  ds_read_b64_tr_b16 v[94:95], v112 offset:832
  ds_read_b64_tr_b16 v[96:97], v112 offset:1024
  ds_read_b64_tr_b16 v[98:99], v112 offset:1088
  ds_read_b64_tr_b16 v[100:101], v112 offset:1280
  ds_read_b64_tr_b16 v[102:103], v112 offset:1344
  s_waitcnt lgkmcnt(8)
  v_mfma_f32_16x16x32_f16 v[48:51], v[80:83], v[24:27], 0
  v_mfma_f32_16x16x32_f16 v[52:55], v[80:83], v[16:19], 0
  v_mfma_f32_16x16x32_f16 v[56:59], v[80:83], v[8:11], 0
  ds_read_b64_tr_b16 v[104:105], v112 offset:1536
  ds_read_b64_tr_b16 v[106:107], v112 offset:1600
  v_mfma_f32_16x16x32_f16 v[52:55], v[84:87], v[20:23], v[52:55]
  v_mfma_f32_16x16x32_f16 v[56:59], v[84:87], v[12:15], v[56:59]
  v_mfma_f32_16x16x32_f16 v[60:63], v[84:87], v[4:7], 0
  ds_read_b64_tr_b16 v[108:109], v112 offset:1792
  ds_read_b64_tr_b16 v[110:111], v112 offset:1856
  s_waitcnt lgkmcnt(8)
  v_mfma_f32_16x16x32_f16 v[52:55], v[88:91], v[24:27], v[52:55]
  v_mfma_f32_16x16x32_f16 v[56:59], v[88:91], v[16:19], v[56:59]
  v_mfma_f32_16x16x32_f16 v[60:63], v[88:91], v[8:11], v[60:63]
  ds_read_b64_tr_b16 v[80:81], v112 offset:2048
  ds_read_b64_tr_b16 v[82:83], v112 offset:2112
  v_mfma_f32_16x16x32_f16 v[56:59], v[92:95], v[20:23], v[56:59]
  v_mfma_f32_16x16x32_f16 v[60:63], v[92:95], v[12:15], v[60:63]
  v_mfma_f32_16x16x32_f16 v[64:67], v[92:95], v[4:7], 0
  ds_read_b64_tr_b16 v[84:85], v112 offset:2304
  ds_read_b64_tr_b16 v[86:87], v112 offset:2368
  s_waitcnt lgkmcnt(8)
  v_mfma_f32_16x16x32_f16 v[56:59], v[96:99], v[24:27], v[56:59]
  v_mfma_f32_16x16x32_f16 v[60:63], v[96:99], v[16:19], v[60:63]
  v_mfma_f32_16x16x32_f16 v[64:67], v[96:99], v[8:11], v[64:67]
  ds_read_b64_tr_b16 v[88:89], v112 offset:2560
  ds_read_b64_tr_b16 v[90:91], v112 offset:2624
  v_mfma_f32_16x16x32_f16 v[60:63], v[100:103], v[20:23], v[60:63]
  v_mfma_f32_16x16x32_f16 v[64:67], v[100:103], v[12:15], v[64:67]
  v_mfma_f32_16x16x32_f16 v[68:71], v[100:103], v[4:7], 0
  ds_read_b64_tr_b16 v[92:93], v112 offset:2816
  ds_read_b64_tr_b16 v[94:95], v112 offset:2880
  s_waitcnt lgkmcnt(8)
  v_mfma_f32_16x16x32_f16 v[60:63], v[104:107], v[24:27], v[60:63]
  v_mfma_f32_16x16x32_f16 v[64:67], v[104:107], v[16:19], v[64:67]
  v_mfma_f32_16x16x32_f16 v[68:71], v[104:107], v[8:11], v[68:71]
  ds_read_b64_tr_b16 v[96:97], v112 offset:3072
  ds_read_b64_tr_b16 v[98:99], v112 offset:3136
  v_mfma_f32_16x16x32_f16 v[64:67], v[108:111], v[20:23], v[64:67]
  v_mfma_f32_16x16x32_f16 v[68:71], v[108:111], v[12:15], v[68:71]
  v_mfma_f32_16x16x32_f16 v[72:75], v[108:111], v[4:7], 0
  ds_read_b64_tr_b16 v[100:101], v115 offset:0
  ds_read_b64_tr_b16 v[102:103], v115 offset:128
  s_waitcnt lgkmcnt(8)
  v_mfma_f32_16x16x32_f16 v[64:67], v[80:83], v[24:27], v[64:67]
  v_mfma_f32_16x16x32_f16 v[68:71], v[80:83], v[16:19], v[68:71]
  v_mfma_f32_16x16x32_f16 v[72:75], v[80:83], v[8:11], v[72:75]
  ds_read_b64_tr_b16 v[104:105], v115 offset:512
  ds_read_b64_tr_b16 v[106:107], v115 offset:640
  v_mfma_f32_16x16x32_f16 v[68:71], v[84:87], v[20:23], v[68:71]
  v_mfma_f32_16x16x32_f16 v[72:75], v[84:87], v[12:15], v[72:75]
  ds_read_b64_tr_b16 v[108:109], v115 offset:1024
  ds_read_b64_tr_b16 v[110:111], v115 offset:1152
  s_waitcnt lgkmcnt(8)
  v_mfma_f32_16x16x32_f16 v[68:71], v[88:91], v[24:27], v[68:71]
  v_mfma_f32_16x16x32_f16 v[72:75], v[88:91], v[16:19], v[72:75]
  ds_read_b64_tr_b16 v[80:81], v115 offset:1536
  ds_read_b64_tr_b16 v[82:83], v115 offset:1664
  v_mfma_f32_16x16x32_f16 v[72:75], v[92:95], v[20:23], v[72:75]
  ds_read_b64_tr_b16 v[84:85], v115 offset:2048
  ds_read_b64_tr_b16 v[86:87], v115 offset:2176
  s_waitcnt lgkmcnt(8)
  v_mfma_f32_16x16x32_f16 v[72:75], v[96:99], v[24:27], v[72:75]
  v_mfma_f32_16x16x32_f16 v[56:59], v[100:103], v[44:47], v[56:59]
  v_mfma_f32_16x16x32_f16 v[60:63], v[100:103], v[40:43], v[60:63]
  v_mfma_f32_16x16x32_f16 v[64:67], v[100:103], v[36:39], v[64:67]
  v_mfma_f32_16x16x32_f16 v[68:71], v[100:103], v[32:35], v[68:71]
  v_mfma_f32_16x16x32_f16 v[72:75], v[100:103], v[28:31], v[72:75]
  s_waitcnt lgkmcnt(4)
  v_mfma_f32_16x16x32_f16 v[60:63], v[104:107], v[44:47], v[60:63]
  v_mfma_f32_16x16x32_f16 v[64:67], v[104:107], v[40:43], v[64:67]
  v_mfma_f32_16x16x32_f16 v[68:71], v[104:107], v[36:39], v[68:71]
  v_mfma_f32_16x16x32_f16 v[72:75], v[104:107], v[32:35], v[72:75]
  v_mfma_f32_16x16x32_f16 v[64:67], v[108:111], v[44:47], v[64:67]
  v_mfma_f32_16x16x32_f16 v[68:71], v[108:111], v[40:43], v[68:71]
  v_mfma_f32_16x16x32_f16 v[72:75], v[108:111], v[36:39], v[72:75]
  s_waitcnt lgkmcnt(0)
  v_mfma_f32_16x16x32_f16 v[68:71], v[80:83], v[44:47], v[68:71]
  v_mfma_f32_16x16x32_f16 v[72:75], v[80:83], v[40:43], v[72:75]
  v_mfma_f32_16x16x32_f16 v[72:75], v[84:87], v[44:47], v[72:75]
  s_nop 1
  ds_write_b128 v117, v[48:51] offset:31456
  ds_write_b128 v117, v[52:55] offset:32480
  ds_write_b128 v117, v[56:59] offset:33504
  ds_write_b128 v117, v[60:63] offset:34528
  ds_write_b128 v117, v[64:67] offset:35552
  ds_write_b128 v117, v[68:71] offset:36576
  ds_write_b128 v117, v[72:75] offset:37600
  s_waitcnt lgkmcnt(0)
  s_barrier
  s_branch k12_kernel_fin
k12_kernel_fin:
  s_endpgm
k12_kernel_ln2:
k12_kernel_done:
  s_endpgm
.p2align 8
code_pf_begin:
.globl k3_kernel
.p2align 8
.type k3_kernel,@function
k3_kernel:
  s_cmp_ge_u32 s2, 256
  s_cbranch_scc1 k3_kernel_done
  s_load_dwordx2 s[4:5], s[0:1], 0
  s_load_dwordx2 s[50:51], s[0:1], 64
  s_mov_b32 s49, s2
  s_and_b32 s16, s2, 7
  s_lshl_b32 s16, s16, 1
  s_bfe_u32 s17, s2, 0x10003
  s_add_u32 s16, s16, s17
  s_and_b32 s2, s2, 0xf0
  s_add_u32 s2, s2, s16
  s_load_dwordx2 s[6:7], s[0:1], 112
  s_load_dwordx2 s[28:29], s[0:1], 48
  v_lshrrev_b32 v1, 6, v0
  v_and_b32 v2, 7, v0
  v_readfirstlane_b32 s3, v1
  v_and_b32 v1, 63, v0
  v_lshrrev_b32 v3, 3, v1
  s_lshl_b32 s16, s2, 3
  v_add_u32 v4, s16, v2
  v_lshlrev_b32 v5, 3, v4
  v_mul_u32_u24 v4, 1280, v4
  s_mul_i32 s17, s3, 128
  v_lshl_add_u32 v6, v3, 4, s17
  v_add_u32 v4, v4, v6
  v_lshlrev_b32 v7, 4, v1
  s_mul_i32 s19, s3, 1024
  s_lshr_b32 s18, s2, 1
  s_mul_i32 s18, s18, 20608
  s_and_b32 s44, s2, 1
  s_lshl_b32 s44, s44, 4
  s_add_u32 s18, s18, s44
  v_lshlrev_b32 v72, 5, v0
  s_add_u32 m0, s19, 0
  s_mov_b32 s10, 2637824
  s_mov_b32 s11, 0x00020000
  s_mov_b32 s14, 2621440
  s_mov_b32 s15, 0x00020000
  s_mov_b32 s22, 16384
  s_mov_b32 s23, 0x00020000
  s_mov_b32 s26, 1280
  s_mov_b32 s27, 0x00020000
  s_waitcnt lgkmcnt(0)
  s_add_u32 s8, s6, 4194304
  s_addc_u32 s9, s7, 0
  s_mov_b32 s12, s4
  s_mov_b32 s13, s5
  buffer_load_dwordx4 v[16:19], v4, s[12:15], 0 offen
  s_add_u32 s20, s6, 29360128
  s_addc_u32 s21, s7, 0
  buffer_load_dwordx2 v[14:15], v5, s[20:23], 0 offen
  s_mov_b32 s24, s28
  s_mov_b32 s25, s29
  buffer_load_dwordx4 v[20:23], v6, s[24:27], 0 offen
  buffer_load_dwordx4 v72, s[8:11], s18 offen offset:0 lds
  s_add_u32 s32, s6, 8388608
  s_addc_u32 s33, s7, 0
  s_mov_b32 s34, 2621440
  s_mov_b32 s35, 0x00020000
  s_add_u32 s36, s6, 12582912
  s_addc_u32 s37, s7, 0
  s_mov_b32 s38, 2622464
  s_mov_b32 s39, 0x00020000
  v_lshrrev_b32 v8, 4, v1
  v_lshlrev_b32 v8, 8, v8
  v_bfe_u32 v9, v1, 1, 1
  v_lshl_add_u32 v8, v9, 7, v8
  v_bfe_u32 v9, v1, 2, 2
  v_lshl_add_u32 v8, v9, 4, v8
  v_and_b32 v10, 1, v1
  v_lshl_add_u32 v8, v10, 3, v8
  v_add_u32 v8, s19, v8
  s_mul_i32 s40, s3, 1152
  s_add_u32 s40, s40, 10240
  v_mul_u32_u24 v10, 144, v2
  v_lshl_add_u32 v10, v3, 4, v10
  v_add_u32 v10, s40, v10
  v_mul_u32_u24 v11, 144, v9
  v_lshrrev_b32 v12, 4, v1
  v_lshl_add_u32 v11, v12, 5, v11
  v_and_b32 v12, 3, v1
  v_lshl_add_u32 v11, v12, 3, v11
  v_add_u32 v11, s40, v11
  v_mul_u32_u24 v12, 96, v2
  v_add_u32 v12, 21760, v12
  v_lshrrev_b32 v13, 5, v1
  v_lshl_add_u32 v13, v13, 2, v12
  s_lshl_b32 s41, s3, 3
  v_add_u32 v13, s41, v13
  s_mul_i32 s47, s2, 1280
  s_mul_i32 s42, s3, 64
  v_add_u32 v52, s42, v1

  v_mul_u32_u24 v53, 52429, v52
  v_lshrrev_b32 v53, 22, v53
  v_mul_u32_u24 v53, 326528, v53
  v_lshl_add_u32 v76, v52, 4, v53
  s_waitcnt vmcnt(2)
  v_lshlrev_b32 v28, 16, v16
  v_and_b32 v29, 0xffff0000, v16
  v_lshlrev_b32 v30, 16, v17
  v_and_b32 v31, 0xffff0000, v17
  v_lshlrev_b32 v32, 16, v18
  v_and_b32 v33, 0xffff0000, v18
  v_lshlrev_b32 v34, 16, v19
  v_and_b32 v35, 0xffff0000, v19
  v_pk_add_f32 v[36:37], v[28:29], v[14:15] op_sel_hi:[1,0] neg_lo:[0,1] neg_hi:[0,1]
  v_pk_add_f32 v[38:39], v[30:31], v[14:15] op_sel_hi:[1,0] neg_lo:[0,1] neg_hi:[0,1]
  v_pk_add_f32 v[40:41], v[32:33], v[14:15] op_sel_hi:[1,0] neg_lo:[0,1] neg_hi:[0,1]
  v_pk_add_f32 v[42:43], v[34:35], v[14:15] op_sel_hi:[1,0] neg_lo:[0,1] neg_hi:[0,1]
  v_cvt_pk_bf16_f32 v52, v36, v37
  v_cvt_pk_bf16_f32 v53, v38, v39
  v_cvt_pk_bf16_f32 v54, v40, v41
  v_cvt_pk_bf16_f32 v55, v42, v43
  v_lshlrev_b32 v36, 16, v52
  v_and_b32 v37, 0xffff0000, v52
  v_lshlrev_b32 v38, 16, v53
  v_and_b32 v39, 0xffff0000, v53
  v_lshlrev_b32 v40, 16, v54
  v_and_b32 v41, 0xffff0000, v54
  v_lshlrev_b32 v42, 16, v55
  v_and_b32 v43, 0xffff0000, v55
  v_pk_mul_f32 v[36:37], v[36:37], v[14:15] op_sel:[0,1] op_sel_hi:[1,1]
  v_pk_mul_f32 v[38:39], v[38:39], v[14:15] op_sel:[0,1] op_sel_hi:[1,1]
  v_pk_mul_f32 v[40:41], v[40:41], v[14:15] op_sel:[0,1] op_sel_hi:[1,1]
  v_pk_mul_f32 v[42:43], v[42:43], v[14:15] op_sel:[0,1] op_sel_hi:[1,1]
  v_cvt_pk_bf16_f32 v52, v36, v37
  v_cvt_pk_bf16_f32 v53, v38, v39
  v_cvt_pk_bf16_f32 v54, v40, v41
  v_cvt_pk_bf16_f32 v55, v42, v43
  v_lshlrev_b32 v36, 16, v52
  v_and_b32 v37, 0xffff0000, v52
  v_lshlrev_b32 v38, 16, v53
  v_and_b32 v39, 0xffff0000, v53
  v_lshlrev_b32 v40, 16, v54
  v_and_b32 v41, 0xffff0000, v54
  v_lshlrev_b32 v42, 16, v55
  v_and_b32 v43, 0xffff0000, v55
  s_waitcnt vmcnt(1)
  v_lshlrev_b32 v44, 16, v20
  v_and_b32 v45, 0xffff0000, v20
  v_lshlrev_b32 v46, 16, v21
  v_and_b32 v47, 0xffff0000, v21
  v_lshlrev_b32 v48, 16, v22
  v_and_b32 v49, 0xffff0000, v22
  v_lshlrev_b32 v50, 16, v23
  v_and_b32 v51, 0xffff0000, v23
  v_pk_mul_f32 v[36:37], v[36:37], v[44:45]
  v_pk_mul_f32 v[38:39], v[38:39], v[46:47]
  v_pk_mul_f32 v[40:41], v[40:41], v[48:49]
  v_pk_mul_f32 v[42:43], v[42:43], v[50:51]
  v_cvt_pk_bf16_f32 v52, v36, v37
  v_cvt_pk_bf16_f32 v53, v38, v39
  v_cvt_pk_bf16_f32 v54, v40, v41
  v_cvt_pk_bf16_f32 v55, v42, v43
  v_lshlrev_b32 v36, 16, v52
  v_and_b32 v37, 0xffff0000, v52
  v_lshlrev_b32 v38, 16, v53
  v_and_b32 v39, 0xffff0000, v53
  v_lshlrev_b32 v40, 16, v54
  v_and_b32 v41, 0xffff0000, v54
  v_lshlrev_b32 v42, 16, v55
  v_and_b32 v43, 0xffff0000, v55
  s_waitcnt vmcnt(0)
  ds_read_b64_tr_b16 v[24:25], v8 offset:0
  ds_read_b64_tr_b16 v[26:27], v8 offset:64
  s_waitcnt lgkmcnt(0)
  v_lshlrev_b32 v44, 16, v24
  v_and_b32 v45, 0xffff0000, v24
  v_lshlrev_b32 v46, 16, v25
  v_and_b32 v47, 0xffff0000, v25
  v_lshlrev_b32 v48, 16, v26
  v_and_b32 v49, 0xffff0000, v26
  v_lshlrev_b32 v50, 16, v27
  v_and_b32 v51, 0xffff0000, v27
  v_pk_add_f32 v[44:45], v[44:45], v[36:37]
  v_pk_add_f32 v[46:47], v[46:47], v[38:39]
  v_pk_add_f32 v[48:49], v[48:49], v[40:41]
  v_pk_add_f32 v[50:51], v[50:51], v[42:43]
  v_cvt_pk_bf16_f32 v52, v44, v45
  v_cvt_pk_bf16_f32 v53, v46, v47
  v_cvt_pk_bf16_f32 v54, v48, v49
  v_cvt_pk_bf16_f32 v55, v50, v51
  v_lshlrev_b32 v44, 16, v52
  v_and_b32 v45, 0xffff0000, v52
  v_lshlrev_b32 v46, 16, v53
  v_and_b32 v47, 0xffff0000, v53
  v_lshlrev_b32 v48, 16, v54
  v_and_b32 v49, 0xffff0000, v54
  v_lshlrev_b32 v50, 16, v55
  v_and_b32 v51, 0xffff0000, v55
  v_pk_add_f32 v[28:29], v[28:29], v[44:45]
  v_pk_add_f32 v[30:31], v[30:31], v[46:47]
  v_pk_add_f32 v[32:33], v[32:33], v[48:49]
  v_pk_add_f32 v[34:35], v[34:35], v[50:51]
  v_cvt_pk_bf16_f32 v16, v28, v29
  v_cvt_pk_bf16_f32 v17, v30, v31
  v_cvt_pk_bf16_f32 v18, v32, v33
  v_cvt_pk_bf16_f32 v19, v34, v35
  buffer_store_dwordx4 v[16:19], v4, s[32:35], 0 offen sc1
  v_lshlrev_b32 v28, 16, v16
  v_and_b32 v29, 0xffff0000, v16
  v_lshlrev_b32 v30, 16, v17
  v_and_b32 v31, 0xffff0000, v17
  v_lshlrev_b32 v32, 16, v18
  v_and_b32 v33, 0xffff0000, v18
  v_lshlrev_b32 v34, 16, v19
  v_and_b32 v35, 0xffff0000, v19
  v_pk_add_f32 v[28:29], v[28:29], v[14:15] op_sel_hi:[1,0] neg_lo:[0,1] neg_hi:[0,1]
  v_pk_add_f32 v[30:31], v[30:31], v[14:15] op_sel_hi:[1,0] neg_lo:[0,1] neg_hi:[0,1]
  v_pk_add_f32 v[32:33], v[32:33], v[14:15] op_sel_hi:[1,0] neg_lo:[0,1] neg_hi:[0,1]
  v_pk_add_f32 v[34:35], v[34:35], v[14:15] op_sel_hi:[1,0] neg_lo:[0,1] neg_hi:[0,1]
  v_pk_add_f32 v[52:53], v[28:29], v[30:31]
  v_pk_add_f32 v[54:55], v[32:33], v[34:35]
  v_pk_mul_f32 v[56:57], v[28:29], v[28:29]
  v_pk_mul_f32 v[58:59], v[30:31], v[30:31]
  v_pk_fma_f32 v[56:57], v[32:33], v[32:33], v[56:57]
  v_pk_fma_f32 v[58:59], v[34:35], v[34:35], v[58:59]
  v_pk_add_f32 v[52:53], v[52:53], v[54:55]
  v_pk_add_f32 v[56:57], v[56:57], v[58:59]
  s_mov_b32 s42, 0xff
  v_add_f32 v52, v52, v53
  v_add_f32 v53, v56, v57
  s_mov_b32 s43, 0xff
  s_nop 0
  v_permlane32_swap_b32 v52, v53
  s_nop 1
  v_add_f32 v52, v52, v53
  v_mov_b32 v53, v52
  s_nop 1
  v_permlane16_swap_b32 v52, v53
  s_nop 1
  v_add_f32 v52, v52, v53
  s_nop 1
  v_add_f32 v52, v52, v52 row_ror:8
  s_mov_b64 exec, s[42:43]
  ds_write_b32 v13, v52
  s_mov_b64 exec, -1
  s_waitcnt lgkmcnt(0)
  s_barrier
  ds_read_b128 v[52:55], v12 offset:0
  ds_read_b128 v[56:59], v12 offset:16
  ds_read_b128 v[60:63], v12 offset:32
  ds_read_b128 v[64:67], v12 offset:48
  ds_read_b128 v[68:71], v12 offset:64
  s_waitcnt lgkmcnt(0)
  v_pk_add_f32 v[52:53], v[52:53], v[54:55]
  v_pk_add_f32 v[56:57], v[56:57], v[58:59]
  v_pk_add_f32 v[60:61], v[60:61], v[62:63]
  v_pk_add_f32 v[64:65], v[64:65], v[66:67]
  v_pk_add_f32 v[68:69], v[68:69], v[70:71]
  v_pk_add_f32 v[52:53], v[52:53], v[56:57]
  v_pk_add_f32 v[60:61], v[60:61], v[64:65]
  v_pk_add_f32 v[52:53], v[52:53], v[60:61]
  v_pk_add_f32 v[52:53], v[52:53], v[68:69]
  s_mov_b32 s42, 0x3acccccd
  v_mul_f32 v52, s42, v52
  v_mul_f32 v53, s42, v53
  v_fma_f32 v53, -v52, v52, v53
  v_max_f32 v53, 0, v53
  v_add_f32 v54, v52, v14
  v_cvt_pk_bf16_f32 v55, v53, v54
  v_lshlrev_b32 v56, 16, v55
  v_and_b32 v55, 0xffff0000, v55
  v_add_f32 v56, 0x3727c5ac, v56
  v_cvt_pk_bf16_f32 v56, v56, v56
  v_lshlrev_b32 v56, 16, v56
  v_sqrt_f32 v56, v56
  v_sub_f32 v57, v55, v14
  v_cvt_pk_bf16_f32 v56, v56, v56
  v_lshlrev_b32 v56, 16, v56
  v_rcp_f32 v56, v56
  v_sub_f32 v58, v52, v57
  v_mul_f32 v58, v58, v56
  v_mul_f32 v59, v53, v56
  v_mul_f32 v59, v59, v56
  v_cvt_pk_bf16_f32 v59, v59, v58
  v_and_b32 v58, 0xffff0000, v59
  v_lshlrev_b32 v59, 16, v59
  v_add_f32 v59, 0x3727c5ac, v59
  v_cvt_pk_bf16_f32 v59, v59, v59
  v_lshlrev_b32 v59, 16, v59
  v_sqrt_f32 v59, v59
  v_fma_f32 v58, v57, v56, v58
  v_cvt_pk_bf16_f32 v59, v59, v59
  v_lshlrev_b32 v59, 16, v59
  v_rcp_f32 v59, v59
  s_nop 0
  v_mul_f32 v60, v56, v59
  v_mul_f32 v62, v58, v59
  v_pk_fma_f32 v[28:29], v[28:29], v[60:61], v[62:63] op_sel_hi:[1,0,0] neg_lo:[0,0,1] neg_hi:[0,0,1]
  v_pk_fma_f32 v[30:31], v[30:31], v[60:61], v[62:63] op_sel_hi:[1,0,0] neg_lo:[0,0,1] neg_hi:[0,0,1]
  v_pk_fma_f32 v[32:33], v[32:33], v[60:61], v[62:63] op_sel_hi:[1,0,0] neg_lo:[0,0,1] neg_hi:[0,0,1]
  v_pk_fma_f32 v[34:35], v[34:35], v[60:61], v[62:63] op_sel_hi:[1,0,0] neg_lo:[0,0,1] neg_hi:[0,0,1]
  v_cvt_pk_bf16_f32 v36, v28, v29
  v_cvt_pk_bf16_f32 v37, v30, v31
  v_cvt_pk_bf16_f32 v38, v32, v33
  v_cvt_pk_bf16_f32 v39, v34, v35
  ds_write_b128 v10, v[36:39]
  ds_read_b64_tr_b16 v[44:45], v11 offset:0
  ds_read_b64_tr_b16 v[46:47], v11 offset:576
  s_waitcnt lgkmcnt(0)
  buffer_store_dwordx4 v[44:47], v76, s[36:39], s47 offen sc1
k3_kernel_done:
  s_endpgm
.globl gemm1_kernel
.p2align 8
.type gemm1_kernel,@function
gemm1_kernel:
  s_cmp_ge_u32 s2, 256
  s_cbranch_scc1 gemm1_kernel_done

  s_load_dwordx2 s[4:5], s[0:1], 64
  s_load_dwordx2 s[6:7], s[0:1], 112
  v_lshrrev_b32 v1, 6, v0
  s_and_b32 s32, s2, 7
  s_lshr_b32 s33, s2, 3
  v_readfirstlane_b32 s3, v1
  v_and_b32 v1, 63, v0
  s_add_u32 s34, s33, 0
  s_and_b32 s34, s34, 7
  s_lshr_b32 s39, s33, 3
  s_and_b32 s35, s32, 1
  s_lshl_b32 s35, s35, 2
  s_add_u32 s33, s39, s35
  s_lshr_b32 s32, s32, 1
  s_mul_i32 s32, s32, 7
  s_add_u32 s32, s32, s34

  s_mul_i32 s40, s33, 327808
  s_add_u32 s40, s40, 12582912
  s_cmp_ge_u32 s34, 7
  s_cbranch_scc1 gemm1_kernel_idle
  s_cmp_ge_u32 s32, 27
  s_cbranch_scc1 gemm1_kernel_idle
  s_cmp_lt_u32 s3, 4
  s_cbranch_scc1 gemm1_kernel_consumer
  s_cmp_eq_u32 s3, 7
  s_cbranch_scc1 gemm1_kernel_toucher
  s_lshl_b32 s29, s39, 1
  s_add_u32 s29, s29, s34
  s_and_b32 s29, s29, 7
  s_lshl_b32 s29, s29, 1
  s_and_b32 s36, s2, 0
  s_add_u32 s29, s29, s36
  s_mul_i32 s29, s29, 0
  s_lshr_b32 s29, s29, 4

  v_lshlrev_b32 v2, 4, v1
  v_lshrrev_b32 v10, 3, v1
  v_mul_u32_u24 v10, 3456, v10
  v_and_b32 v11, 7, v1
  v_bfe_u32 v12, v1, 4, 1
  v_lshlrev_b32 v12, 1, v12
  v_xor_b32 v11, v11, v12
  s_lshl_b32 s36, s32, 7
  v_add_u32 v10, s36, v10
  v_lshl_add_u32 v3, v11, 4, v10
  v_xor_b32 v11, 4, v11
  v_lshl_add_u32 v4, v11, 4, v10
  v_add_u32 v4, 26624, v4
  v_add_u32 v5, 53248, v3
  v_add_u32 v6, 53248, v4
  s_waitcnt lgkmcnt(0)
  s_mov_b32 s8, s4
  s_mov_b32 s9, s5
  s_mov_b32 s10, 7077888
  s_mov_b32 s11, 0x00020000
  s_add_u32 s12, s6, s40
  s_addc_u32 s13, s7, 0
  s_mov_b32 s14, 327680
  s_mov_b32 s15, 0x00020000
  s_cmp_lg_u32 s3, 4
  s_cbranch_scc1 gemm1_kernel_ld1
  s_mul_i32 s24, s29, 10240
  s_mul_i32 s25, s29, 10240
  s_add_u32 s24, s24, 0
  s_add_u32 s25, s25, 4096
  s_mov_b32 s26, 0
  s_mov_b32 s28, 4
gemm1_kernel_ld0_pro:
  s_add_u32 m0, s26, 0
  s_add_u32 s27, s26, 18432
  buffer_load_dwordx4 v2, s[12:15], s24 offen offset:0  lds
  buffer_load_dwordx4 v2, s[12:15], s24 offen offset:1024  lds
  buffer_load_dwordx4 v2, s[12:15], s24 offen offset:2048  lds
  buffer_load_dwordx4 v2, s[12:15], s24 offen offset:3072  lds
  s_add_u32 m0, s26, 4096
  s_cmp_ge_u32 s27, 92160
  buffer_load_dwordx4 v2, s[12:15], s25 offen offset:0  lds
  buffer_load_dwordx4 v2, s[12:15], s25 offen offset:1024  lds
  s_cselect_b32 s26, 0, s27
  s_add_u32 s24, s24, 10240
  s_add_u32 s25, s25, 10240
  s_add_u32 s29, s29, 1
  s_cmp_eq_u32 s29, 32
  s_cselect_b32 s29, 0, s29
  s_cselect_b32 s24, 0, s24
  s_cselect_b32 s25, 4096, s25
  s_sub_u32 s28, s28, 1
  s_cmp_lg_u32 s28, 0
  s_cbranch_scc1 gemm1_kernel_ld0_pro
  s_mov_b32 s28, 28
gemm1_kernel_ld0_loop:
  s_waitcnt vmcnt(18)
  s_barrier
  s_add_u32 m0, s26, 0
  s_add_u32 s27, s26, 18432
  buffer_load_dwordx4 v2, s[12:15], s24 offen offset:0  lds
  buffer_load_dwordx4 v2, s[12:15], s24 offen offset:1024  lds
  buffer_load_dwordx4 v2, s[12:15], s24 offen offset:2048  lds
  buffer_load_dwordx4 v2, s[12:15], s24 offen offset:3072  lds
  s_add_u32 m0, s26, 4096
  s_cmp_ge_u32 s27, 92160
  buffer_load_dwordx4 v2, s[12:15], s25 offen offset:0  lds
  buffer_load_dwordx4 v2, s[12:15], s25 offen offset:1024  lds
  s_cselect_b32 s26, 0, s27
  s_add_u32 s24, s24, 10240
  s_add_u32 s25, s25, 10240
  s_add_u32 s29, s29, 1
  s_cmp_eq_u32 s29, 32
  s_cselect_b32 s29, 0, s29
  s_cselect_b32 s24, 0, s24
  s_cselect_b32 s25, 4096, s25
  s_sub_u32 s28, s28, 1
  s_cmp_lg_u32 s28, 0
  s_cbranch_scc1 gemm1_kernel_ld0_loop
  s_waitcnt vmcnt(18)
  s_barrier
  s_waitcnt vmcnt(12)
  s_barrier
  s_waitcnt vmcnt(6)
  s_barrier
  s_waitcnt vmcnt(0)
  s_barrier
  s_endpgm
gemm1_kernel_ld1:
  s_cmp_lg_u32 s3, 5
  s_cbranch_scc1 gemm1_kernel_ld2
  s_mul_i32 s24, s29, 10240
  s_mul_i32 s25, s29, 221184
  s_add_u32 s24, s24, 6144
  s_add_u32 s25, s25, 0
  s_mov_b32 s26, 0
  s_mov_b32 s28, 4
gemm1_kernel_ld1_pro:
  s_add_u32 m0, s26, 6144
  s_add_u32 s27, s26, 18432
  buffer_load_dwordx4 v2, s[12:15], s24 offen offset:0  lds
  buffer_load_dwordx4 v2, s[12:15], s24 offen offset:1024  lds
  buffer_load_dwordx4 v2, s[12:15], s24 offen offset:2048  lds
  buffer_load_dwordx4 v2, s[12:15], s24 offen offset:3072  lds
  s_add_u32 m0, s26, 10240
  s_cmp_ge_u32 s27, 92160
  buffer_load_dwordx4 v3, s[8:11], s25 offen offset:0  lds
  buffer_load_dwordx4 v4, s[8:11], s25 offen offset:1024  lds
  s_cselect_b32 s26, 0, s27
  s_add_u32 s24, s24, 10240
  s_add_u32 s25, s25, 221184
  s_add_u32 s29, s29, 1
  s_cmp_eq_u32 s29, 32
  s_cselect_b32 s29, 0, s29
  s_cselect_b32 s24, 6144, s24
  s_cselect_b32 s25, 0, s25
  s_sub_u32 s28, s28, 1
  s_cmp_lg_u32 s28, 0
  s_cbranch_scc1 gemm1_kernel_ld1_pro
  s_mov_b32 s28, 28
gemm1_kernel_ld1_loop:
  s_waitcnt vmcnt(18)
  s_barrier
  s_add_u32 m0, s26, 6144
  s_add_u32 s27, s26, 18432
  buffer_load_dwordx4 v2, s[12:15], s24 offen offset:0  lds
  buffer_load_dwordx4 v2, s[12:15], s24 offen offset:1024  lds
  buffer_load_dwordx4 v2, s[12:15], s24 offen offset:2048  lds
  buffer_load_dwordx4 v2, s[12:15], s24 offen offset:3072  lds
  s_add_u32 m0, s26, 10240
  s_cmp_ge_u32 s27, 92160
  buffer_load_dwordx4 v3, s[8:11], s25 offen offset:0  lds
  buffer_load_dwordx4 v4, s[8:11], s25 offen offset:1024  lds
  s_cselect_b32 s26, 0, s27
  s_add_u32 s24, s24, 10240
  s_add_u32 s25, s25, 221184
  s_add_u32 s29, s29, 1
  s_cmp_eq_u32 s29, 32
  s_cselect_b32 s29, 0, s29
  s_cselect_b32 s24, 6144, s24
  s_cselect_b32 s25, 0, s25
  s_sub_u32 s28, s28, 1
  s_cmp_lg_u32 s28, 0
  s_cbranch_scc1 gemm1_kernel_ld1_loop
  s_waitcnt vmcnt(18)
  s_barrier
  s_waitcnt vmcnt(12)
  s_barrier
  s_waitcnt vmcnt(6)
  s_barrier
  s_waitcnt vmcnt(0)
  s_barrier
  s_endpgm
gemm1_kernel_ld2:
  s_mul_i32 s24, s29, 221184
  s_mul_i32 s25, s29, 221184
  s_add_u32 s24, s24, 55296
  s_add_u32 s25, s25, 165888
  s_mov_b32 s26, 0
  s_mov_b32 s28, 4
gemm1_kernel_ld2_pro:
  s_add_u32 m0, s26, 12288
  s_add_u32 s27, s26, 18432
  buffer_load_dwordx4 v3, s[8:11], s24 offen offset:0  lds
  buffer_load_dwordx4 v4, s[8:11], s24 offen offset:1024  lds
  buffer_load_dwordx4 v5, s[8:11], s24 offen offset:2048  lds
  buffer_load_dwordx4 v6, s[8:11], s24 offen offset:3072  lds
  s_add_u32 m0, s26, 16384
  s_cmp_ge_u32 s27, 92160
  buffer_load_dwordx4 v3, s[8:11], s25 offen offset:0  lds
  buffer_load_dwordx4 v4, s[8:11], s25 offen offset:1024  lds
  s_cselect_b32 s26, 0, s27
  s_add_u32 s24, s24, 221184
  s_add_u32 s25, s25, 221184
  s_add_u32 s29, s29, 1
  s_cmp_eq_u32 s29, 32
  s_cselect_b32 s29, 0, s29
  s_cselect_b32 s24, 55296, s24
  s_cselect_b32 s25, 165888, s25
  s_sub_u32 s28, s28, 1
  s_cmp_lg_u32 s28, 0
  s_cbranch_scc1 gemm1_kernel_ld2_pro
  s_mov_b32 s28, 28
gemm1_kernel_ld2_loop:
  s_waitcnt vmcnt(18)
  s_barrier
  s_add_u32 m0, s26, 12288
  s_add_u32 s27, s26, 18432
  buffer_load_dwordx4 v3, s[8:11], s24 offen offset:0  lds
  buffer_load_dwordx4 v4, s[8:11], s24 offen offset:1024  lds
  buffer_load_dwordx4 v5, s[8:11], s24 offen offset:2048  lds
  buffer_load_dwordx4 v6, s[8:11], s24 offen offset:3072  lds
  s_add_u32 m0, s26, 16384
  s_cmp_ge_u32 s27, 92160
  buffer_load_dwordx4 v3, s[8:11], s25 offen offset:0  lds
  buffer_load_dwordx4 v4, s[8:11], s25 offen offset:1024  lds
  s_cselect_b32 s26, 0, s27
  s_add_u32 s24, s24, 221184
  s_add_u32 s25, s25, 221184
  s_add_u32 s29, s29, 1
  s_cmp_eq_u32 s29, 32
  s_cselect_b32 s29, 0, s29
  s_cselect_b32 s24, 55296, s24
  s_cselect_b32 s25, 165888, s25
  s_sub_u32 s28, s28, 1
  s_cmp_lg_u32 s28, 0
  s_cbranch_scc1 gemm1_kernel_ld2_loop
  s_waitcnt vmcnt(18)
  s_barrier
  s_waitcnt vmcnt(12)
  s_barrier
  s_waitcnt vmcnt(6)
  s_barrier
  s_waitcnt vmcnt(0)
  s_barrier
  s_endpgm
gemm1_kernel_toucher:
  s_endpgm
gemm1_kernel_idle:
  s_cmp_ge_u32 s3, 4
  s_cbranch_scc1 gemm1_kernel_idle2
  s_waitcnt lgkmcnt(0)
  s_lshl_b32 s36, s34, 8
  v_add_u32 v5, s36, v0
  v_lshlrev_b32 v5, 7, v5
  s_add_u32 s12, s6, s40
  s_addc_u32 s13, s7, 0
  s_mov_b32 s14, 327680
  s_mov_b32 s15, 0x00020000
gemm1_kernel_idle2:
  s_cmp_lg_u32 s34, 7
  s_cbranch_scc1 gemm1_kernel_done
  s_load_dwordx2 s[20:21], s[0:1], 80
  s_and_b32 s16, s2, 7
  s_lshl_b32 s16, s16, 9
  s_mul_i32 s17, s39, 448
  v_add_u32 v1, s17, v0
  v_lshrrev_b32 v2, 2, v1
  v_lshlrev_b32 v2, 12, v2
  v_and_b32 v3, 3, v1
  v_lshl_add_u32 v2, v3, 7, v2
  v_add_u32 v2, s16, v2
  s_waitcnt lgkmcnt(0)
  s_mov_b32 s8, s20
  s_mov_b32 s9, s21
  s_mov_b32 s10, 7077888
  s_mov_b32 s11, 0x00020000
  s_mov_b32 s36, 0
  buffer_load_dword v4, v2, s[8:11], s36 offen
  s_mov_b32 s36, 1835008
  buffer_load_dword v5, v2, s[8:11], s36 offen
  s_mov_b32 s36, 3670016
  buffer_load_dword v6, v2, s[8:11], s36 offen
  s_mov_b32 s36, 5505024
  buffer_load_dword v7, v2, s[8:11], s36 offen
  s_waitcnt vmcnt(0)
  s_mov_b32 s36, 0
  buffer_load_dword v4, v2, s[8:11], s36 offen
  s_mov_b32 s36, 1835008
  buffer_load_dword v5, v2, s[8:11], s36 offen
  s_mov_b32 s36, 3670016
  buffer_load_dword v6, v2, s[8:11], s36 offen
  s_mov_b32 s36, 5505024
  buffer_load_dword v7, v2, s[8:11], s36 offen
  s_waitcnt vmcnt(0)
  s_waitcnt vmcnt(0)
  s_endpgm
gemm1_kernel_consumer:
  s_load_dwordx2 s[28:29], s[0:1], 72
  s_load_dwordx2 s[30:31], s[0:1], 96
  s_mov_b32 s38, 0
  v_lshrrev_b32 v12, 4, v1
  s_lshl_b32 s36, s38, 2
  v_add_u32 v13, s36, v12
  v_mul_u32_u24 v13, 1280, v13
  v_and_b32 v14, 15, v1
  v_lshl_add_u32 v2, v14, 4, v13
  v_bfe_u32 v13, v1, 2, 2
  v_lshl_add_u32 v14, v12, 3, v13
  v_lshlrev_b32 v14, 7, v14
  v_and_b32 v15, 3, v1
  v_lshl_add_u32 v14, v15, 3, v14
  s_lshl_b32 s36, s38, 12
  s_add_u32 s36, s36, 10240
  v_add_u32 v14, s36, v14
  v_lshrrev_b32 v13, 1, v13
  v_and_b32 v12, 1, v12
  v_lshl_or_b32 v13, v12, 1, v13
  v_xor_b32 v15, s3, v13
  v_lshl_add_u32 v3, v15, 5, v14
  v_add_u32 v14, 0x1000, v14
  v_lshl_add_u32 v4, v15, 5, v14
  s_waitcnt lgkmcnt(0)
  s_lshl_b32 s36, s34, 8
  v_add_u32 v5, s36, v0
  v_lshlrev_b32 v5, 7, v5
  s_add_u32 s12, s6, s40
  s_addc_u32 s13, s7, 0
  s_mov_b32 s14, 327680
  s_mov_b32 s15, 0x00020000
  s_lshl_b32 s36, s39, 8
  v_add_u32 v6, s36, v0
  v_mul_u32_u24 v6, 3456, v6
  s_lshl_b32 s36, s32, 7
  v_add_u32 v6, s36, v6
  s_mov_b32 s8, s4
  s_mov_b32 s9, s5
  s_mov_b32 s10, 7077888
  s_mov_b32 s11, 0x00020000
  s_mul_i32 s36, s33, 276608
  s_add_u32 s36, s36, 16777216
  s_add_u32 s16, s6, s36
  s_addc_u32 s17, s7, 0
  s_mov_b32 s18, 276480
  s_mov_b32 s19, 0x00020000
  s_mov_b32 s20, s28
  s_mov_b32 s21, s29
  s_mov_b32 s22, 3456
  s_mov_b32 s23, 0x00020000
  v_lshrrev_b32 v12, 4, v1
  s_lshl_b32 s36, s32, 6
  s_lshl_b32 s37, s3, 4
  s_add_u32 s36, s36, s37
  v_lshlrev_b32 v13, 2, v12
  v_add_u32 v13, s36, v13
  v_lshlrev_b32 v13, 1, v13
  buffer_load_dwordx2 v[16:17], v13, s[20:23], 0 offen
  s_lshr_b32 s36, s36, 3
  v_lshrrev_b32 v13, 1, v12
  v_add_u32 v13, s36, v13
  v_mul_u32_u24 v13, 1280, v13
  v_and_b32 v14, 15, v1
  v_lshl_add_u32 v13, v14, 4, v13
  v_and_b32 v12, 1, v12
  v_lshl_add_u32 v7, v12, 8, v13
  v_lshl_add_u32 v8, v12, 3, v13
  v_pk_mov_b32 v[128:129], 0, 0
  v_pk_mov_b32 v[130:131], 0, 0
  v_pk_mov_b32 v[132:133], 0, 0
  v_pk_mov_b32 v[134:135], 0, 0
  v_pk_mov_b32 v[136:137], 0, 0
  v_pk_mov_b32 v[138:139], 0, 0
  v_pk_mov_b32 v[140:141], 0, 0
  v_pk_mov_b32 v[142:143], 0, 0
  v_pk_mov_b32 v[144:145], 0, 0
  v_pk_mov_b32 v[146:147], 0, 0
  v_pk_mov_b32 v[148:149], 0, 0
  v_pk_mov_b32 v[150:151], 0, 0
  v_pk_mov_b32 v[152:153], 0, 0
  v_pk_mov_b32 v[154:155], 0, 0
  v_pk_mov_b32 v[156:157], 0, 0
  v_pk_mov_b32 v[158:159], 0, 0
  v_pk_mov_b32 v[160:161], 0, 0
  v_pk_mov_b32 v[162:163], 0, 0
  v_pk_mov_b32 v[164:165], 0, 0
  v_pk_mov_b32 v[166:167], 0, 0
  s_mov_b32 s26, 18432
  s_mul_i32 s36, s3, 5120
  s_add_u32 s36, s36, 55296
  v_lshlrev_b32 v12, 4, v1
  v_add_u32 v28, s36, v12
  s_xor_b32 s36, s3, 1
  s_mul_i32 s36, s36, 5120
  s_add_u32 s36, s36, 55296
  v_add_u32 v29, s36, v12
  s_barrier
  ds_read_b64_tr_b16 v[112:113], v3 offset:0
  ds_read_b64_tr_b16 v[114:115], v3 offset:512
  ds_read_b128 v[32:35], v2 offset:0
  ds_read_b128 v[36:39], v2 offset:256
  ds_read_b128 v[40:43], v2 offset:512
  ds_read_b128 v[44:47], v2 offset:768
  ds_read_b128 v[48:51], v2 offset:1024
  ds_read_b64_tr_b16 v[116:117], v4 offset:0
  ds_read_b64_tr_b16 v[118:119], v4 offset:512
  ds_read_b128 v[52:55], v2 offset:5120
  ds_read_b128 v[56:59], v2 offset:5376
  ds_read_b128 v[60:63], v2 offset:5632
  ds_read_b128 v[64:67], v2 offset:5888
  ds_read_b128 v[68:71], v2 offset:6144
  v_add_u32 v9, s26, v2
  v_add_u32 v10, s26, v3
  v_add_u32 v11, s26, v4
  s_add_u32 s26, s26, 18432
  s_cmp_ge_u32 s26, 92160
  s_cselect_b32 s26, 0, s26
  s_waitcnt lgkmcnt(0)
  s_mov_b32 s27, 15
gemm1_kernel_cloop:
  s_barrier
  ds_read_b64_tr_b16 v[120:121], v10 offset:0
  ds_read_b64_tr_b16 v[122:123], v10 offset:512
  v_mfma_f32_16x16x32_bf16 v[128:131], v[112:115], v[32:35], v[128:131]
  ds_read_b128 v[72:75], v9 offset:0
  ds_read_b128 v[76:79], v9 offset:256
  v_mfma_f32_16x16x32_bf16 v[136:139], v[112:115], v[36:39], v[136:139]
  ds_read_b128 v[80:83], v9 offset:512
  ds_read_b128 v[84:87], v9 offset:768
  v_mfma_f32_16x16x32_bf16 v[144:147], v[112:115], v[40:43], v[144:147]
  ds_read_b128 v[88:91], v9 offset:1024
  ds_read_b64_tr_b16 v[124:125], v11 offset:0
  v_mfma_f32_16x16x32_bf16 v[152:155], v[112:115], v[44:47], v[152:155]
  ds_read_b64_tr_b16 v[126:127], v11 offset:512
  v_mfma_f32_16x16x32_bf16 v[160:163], v[112:115], v[48:51], v[160:163]
  ds_read_b128 v[92:95], v9 offset:5120
  v_mfma_f32_16x16x32_bf16 v[128:131], v[116:119], v[52:55], v[128:131]
  ds_read_b128 v[96:99], v9 offset:5376
  v_mfma_f32_16x16x32_bf16 v[136:139], v[116:119], v[56:59], v[136:139]
  ds_read_b128 v[100:103], v9 offset:5632
  v_mfma_f32_16x16x32_bf16 v[144:147], v[116:119], v[60:63], v[144:147]
  ds_read_b128 v[104:107], v9 offset:5888
  v_mfma_f32_16x16x32_bf16 v[152:155], v[116:119], v[64:67], v[152:155]
  ds_read_b128 v[108:111], v9 offset:6144
  v_mfma_f32_16x16x32_bf16 v[160:163], v[116:119], v[68:71], v[160:163]
  v_add_u32 v9, s26, v2
  v_add_u32 v10, s26, v3
  v_add_u32 v11, s26, v4
  s_add_u32 s26, s26, 18432
  s_cmp_ge_u32 s26, 92160
  s_cselect_b32 s26, 0, s26
  s_waitcnt lgkmcnt(0)
  s_barrier
  ds_read_b64_tr_b16 v[112:113], v10 offset:0
  ds_read_b64_tr_b16 v[114:115], v10 offset:512
  v_mfma_f32_16x16x32_bf16 v[128:131], v[120:123], v[72:75], v[128:131]
  ds_read_b128 v[32:35], v9 offset:0
  ds_read_b128 v[36:39], v9 offset:256
  v_mfma_f32_16x16x32_bf16 v[136:139], v[120:123], v[76:79], v[136:139]
  ds_read_b128 v[40:43], v9 offset:512
  ds_read_b128 v[44:47], v9 offset:768
  v_mfma_f32_16x16x32_bf16 v[144:147], v[120:123], v[80:83], v[144:147]
  ds_read_b128 v[48:51], v9 offset:1024
  ds_read_b64_tr_b16 v[116:117], v11 offset:0
  v_mfma_f32_16x16x32_bf16 v[152:155], v[120:123], v[84:87], v[152:155]
  ds_read_b64_tr_b16 v[118:119], v11 offset:512
  v_mfma_f32_16x16x32_bf16 v[160:163], v[120:123], v[88:91], v[160:163]
  ds_read_b128 v[52:55], v9 offset:5120
  v_mfma_f32_16x16x32_bf16 v[128:131], v[124:127], v[92:95], v[128:131]
  ds_read_b128 v[56:59], v9 offset:5376
  v_mfma_f32_16x16x32_bf16 v[136:139], v[124:127], v[96:99], v[136:139]
  ds_read_b128 v[60:63], v9 offset:5632
  v_mfma_f32_16x16x32_bf16 v[144:147], v[124:127], v[100:103], v[144:147]
  ds_read_b128 v[64:67], v9 offset:5888
  v_mfma_f32_16x16x32_bf16 v[152:155], v[124:127], v[104:107], v[152:155]
  ds_read_b128 v[68:71], v9 offset:6144
  v_mfma_f32_16x16x32_bf16 v[160:163], v[124:127], v[108:111], v[160:163]
  v_add_u32 v9, s26, v2
  v_add_u32 v10, s26, v3
  v_add_u32 v11, s26, v4
  s_add_u32 s26, s26, 18432
  s_cmp_ge_u32 s26, 92160
  s_cselect_b32 s26, 0, s26
  s_waitcnt lgkmcnt(0)
  s_sub_u32 s27, s27, 1
  s_cmp_lg_u32 s27, 0
  s_cbranch_scc1 gemm1_kernel_cloop
  s_barrier
  ds_read_b64_tr_b16 v[120:121], v10 offset:0
  ds_read_b64_tr_b16 v[122:123], v10 offset:512
  v_mfma_f32_16x16x32_bf16 v[128:131], v[112:115], v[32:35], v[128:131]
  ds_read_b128 v[72:75], v9 offset:0
  ds_read_b128 v[76:79], v9 offset:256
  v_mfma_f32_16x16x32_bf16 v[136:139], v[112:115], v[36:39], v[136:139]
  ds_read_b128 v[80:83], v9 offset:512
  ds_read_b128 v[84:87], v9 offset:768
  v_mfma_f32_16x16x32_bf16 v[144:147], v[112:115], v[40:43], v[144:147]
  ds_read_b128 v[88:91], v9 offset:1024
  ds_read_b64_tr_b16 v[124:125], v11 offset:0
  v_mfma_f32_16x16x32_bf16 v[152:155], v[112:115], v[44:47], v[152:155]
  ds_read_b64_tr_b16 v[126:127], v11 offset:512
  v_mfma_f32_16x16x32_bf16 v[160:163], v[112:115], v[48:51], v[160:163]
  ds_read_b128 v[92:95], v9 offset:5120
  v_mfma_f32_16x16x32_bf16 v[128:131], v[116:119], v[52:55], v[128:131]
  ds_read_b128 v[96:99], v9 offset:5376
  v_mfma_f32_16x16x32_bf16 v[136:139], v[116:119], v[56:59], v[136:139]
  ds_read_b128 v[100:103], v9 offset:5632
  v_mfma_f32_16x16x32_bf16 v[144:147], v[116:119], v[60:63], v[144:147]
  ds_read_b128 v[104:107], v9 offset:5888
  v_mfma_f32_16x16x32_bf16 v[152:155], v[116:119], v[64:67], v[152:155]
  ds_read_b128 v[108:111], v9 offset:6144
  v_mfma_f32_16x16x32_bf16 v[160:163], v[116:119], v[68:71], v[160:163]
  v_add_u32 v9, s26, v2
  v_add_u32 v10, s26, v3
  v_add_u32 v11, s26, v4
  s_add_u32 s26, s26, 18432
  s_cmp_ge_u32 s26, 92160
  s_cselect_b32 s26, 0, s26
  s_waitcnt lgkmcnt(0)
  v_mfma_f32_16x16x32_bf16 v[128:131], v[120:123], v[72:75], v[128:131]
  v_mfma_f32_16x16x32_bf16 v[136:139], v[120:123], v[76:79], v[136:139]
  v_mfma_f32_16x16x32_bf16 v[144:147], v[120:123], v[80:83], v[144:147]
  v_mfma_f32_16x16x32_bf16 v[152:155], v[120:123], v[84:87], v[152:155]
  v_mfma_f32_16x16x32_bf16 v[160:163], v[120:123], v[88:91], v[160:163]
  v_mfma_f32_16x16x32_bf16 v[128:131], v[124:127], v[92:95], v[128:131]
  v_mfma_f32_16x16x32_bf16 v[136:139], v[124:127], v[96:99], v[136:139]
  v_mfma_f32_16x16x32_bf16 v[144:147], v[124:127], v[100:103], v[144:147]
  v_mfma_f32_16x16x32_bf16 v[152:155], v[124:127], v[104:107], v[152:155]
  v_mfma_f32_16x16x32_bf16 v[160:163], v[124:127], v[108:111], v[160:163]
  s_waitcnt vmcnt(0)
  v_lshlrev_b32 v18, 16, v16
  v_and_b32 v19, 0xffff0000, v16
  v_lshlrev_b32 v20, 16, v17
  v_and_b32 v21, 0xffff0000, v17
  v_mov_b32 v22, 0xc0135761
  v_mov_b32 v24, 0xbdd2d3e8
  v_mov_b32 v26, 1.0
  s_nop 3
  v_pk_add_f32 v[128:129], v[128:129], v[18:19]
  v_pk_add_f32 v[130:131], v[130:131], v[20:21]
  v_pk_mul_f32 v[132:133], v[128:129], v[128:129]
  v_pk_mul_f32 v[134:135], v[130:131], v[130:131]
  v_pk_fma_f32 v[132:133], v[132:133], v[24:25], v[22:23] op_sel_hi:[1,0,0]
  v_pk_fma_f32 v[134:135], v[134:135], v[24:25], v[22:23] op_sel_hi:[1,0,0]
  v_pk_mul_f32 v[132:133], v[132:133], v[128:129]
  v_pk_mul_f32 v[134:135], v[134:135], v[130:131]
  v_exp_f32 v132, v132
  v_exp_f32 v133, v133
  v_exp_f32 v134, v134
  v_exp_f32 v135, v135
  s_nop 0
  v_pk_add_f32 v[132:133], v[132:133], v[26:27] op_sel_hi:[1,0]
  v_pk_add_f32 v[134:135], v[134:135], v[26:27] op_sel_hi:[1,0]
  v_rcp_f32 v132, v132
  v_rcp_f32 v133, v133
  v_rcp_f32 v134, v134
  v_rcp_f32 v135, v135
  s_nop 0
  v_pk_mul_f32 v[128:129], v[128:129], v[132:133]
  v_pk_mul_f32 v[130:131], v[130:131], v[134:135]
  v_cvt_pk_bf16_f32 v32, v128, v129
  v_cvt_pk_bf16_f32 v33, v130, v131
  v_pk_add_f32 v[136:137], v[136:137], v[18:19]
  v_pk_add_f32 v[138:139], v[138:139], v[20:21]
  v_pk_mul_f32 v[140:141], v[136:137], v[136:137]
  v_pk_mul_f32 v[142:143], v[138:139], v[138:139]
  v_pk_fma_f32 v[140:141], v[140:141], v[24:25], v[22:23] op_sel_hi:[1,0,0]
  v_pk_fma_f32 v[142:143], v[142:143], v[24:25], v[22:23] op_sel_hi:[1,0,0]
  v_pk_mul_f32 v[140:141], v[140:141], v[136:137]
  v_pk_mul_f32 v[142:143], v[142:143], v[138:139]
  v_exp_f32 v140, v140
  v_exp_f32 v141, v141
  v_exp_f32 v142, v142
  v_exp_f32 v143, v143
  s_nop 0
  v_pk_add_f32 v[140:141], v[140:141], v[26:27] op_sel_hi:[1,0]
  v_pk_add_f32 v[142:143], v[142:143], v[26:27] op_sel_hi:[1,0]
  v_rcp_f32 v140, v140
  v_rcp_f32 v141, v141
  v_rcp_f32 v142, v142
  v_rcp_f32 v143, v143
  s_nop 0
  v_pk_mul_f32 v[136:137], v[136:137], v[140:141]
  v_pk_mul_f32 v[138:139], v[138:139], v[142:143]
  v_cvt_pk_bf16_f32 v34, v136, v137
  v_cvt_pk_bf16_f32 v35, v138, v139
  s_nop 1
  v_permlane16_swap_b32 v32, v34
  v_permlane16_swap_b32 v33, v35
  buffer_store_dwordx4 v[32:35], v7, s[16:19], 0 offen offset:0 sc1
  v_pk_add_f32 v[144:145], v[144:145], v[18:19]
  v_pk_add_f32 v[146:147], v[146:147], v[20:21]
  v_pk_mul_f32 v[148:149], v[144:145], v[144:145]
  v_pk_mul_f32 v[150:151], v[146:147], v[146:147]
  v_pk_fma_f32 v[148:149], v[148:149], v[24:25], v[22:23] op_sel_hi:[1,0,0]
  v_pk_fma_f32 v[150:151], v[150:151], v[24:25], v[22:23] op_sel_hi:[1,0,0]
  v_pk_mul_f32 v[148:149], v[148:149], v[144:145]
  v_pk_mul_f32 v[150:151], v[150:151], v[146:147]
  v_exp_f32 v148, v148
  v_exp_f32 v149, v149
  v_exp_f32 v150, v150
  v_exp_f32 v151, v151
  s_nop 0
  v_pk_add_f32 v[148:149], v[148:149], v[26:27] op_sel_hi:[1,0]
  v_pk_add_f32 v[150:151], v[150:151], v[26:27] op_sel_hi:[1,0]
  v_rcp_f32 v148, v148
  v_rcp_f32 v149, v149
  v_rcp_f32 v150, v150
  v_rcp_f32 v151, v151
  s_nop 0
  v_pk_mul_f32 v[144:145], v[144:145], v[148:149]
  v_pk_mul_f32 v[146:147], v[146:147], v[150:151]
  v_cvt_pk_bf16_f32 v36, v144, v145
  v_cvt_pk_bf16_f32 v37, v146, v147
  v_pk_add_f32 v[152:153], v[152:153], v[18:19]
  v_pk_add_f32 v[154:155], v[154:155], v[20:21]
  v_pk_mul_f32 v[156:157], v[152:153], v[152:153]
  v_pk_mul_f32 v[158:159], v[154:155], v[154:155]
  v_pk_fma_f32 v[156:157], v[156:157], v[24:25], v[22:23] op_sel_hi:[1,0,0]
  v_pk_fma_f32 v[158:159], v[158:159], v[24:25], v[22:23] op_sel_hi:[1,0,0]
  v_pk_mul_f32 v[156:157], v[156:157], v[152:153]
  v_pk_mul_f32 v[158:159], v[158:159], v[154:155]
  v_exp_f32 v156, v156
  v_exp_f32 v157, v157
  v_exp_f32 v158, v158
  v_exp_f32 v159, v159
  s_nop 0
  v_pk_add_f32 v[156:157], v[156:157], v[26:27] op_sel_hi:[1,0]
  v_pk_add_f32 v[158:159], v[158:159], v[26:27] op_sel_hi:[1,0]
  v_rcp_f32 v156, v156
  v_rcp_f32 v157, v157
  v_rcp_f32 v158, v158
  v_rcp_f32 v159, v159
  s_nop 0
  v_pk_mul_f32 v[152:153], v[152:153], v[156:157]
  v_pk_mul_f32 v[154:155], v[154:155], v[158:159]
  v_cvt_pk_bf16_f32 v38, v152, v153
  v_cvt_pk_bf16_f32 v39, v154, v155
  s_nop 1
  v_permlane16_swap_b32 v36, v38
  v_permlane16_swap_b32 v37, v39
  buffer_store_dwordx4 v[36:39], v7, s[16:19], 0 offen offset:512 sc1
  v_pk_add_f32 v[160:161], v[160:161], v[18:19]
  v_pk_add_f32 v[162:163], v[162:163], v[20:21]
  v_pk_mul_f32 v[164:165], v[160:161], v[160:161]
  v_pk_mul_f32 v[166:167], v[162:163], v[162:163]
  v_pk_fma_f32 v[164:165], v[164:165], v[24:25], v[22:23] op_sel_hi:[1,0,0]
  v_pk_fma_f32 v[166:167], v[166:167], v[24:25], v[22:23] op_sel_hi:[1,0,0]
  v_pk_mul_f32 v[164:165], v[164:165], v[160:161]
  v_pk_mul_f32 v[166:167], v[166:167], v[162:163]
  v_exp_f32 v164, v164
  v_exp_f32 v165, v165
  v_exp_f32 v166, v166
  v_exp_f32 v167, v167
  s_nop 0
  v_pk_add_f32 v[164:165], v[164:165], v[26:27] op_sel_hi:[1,0]
  v_pk_add_f32 v[166:167], v[166:167], v[26:27] op_sel_hi:[1,0]
  v_rcp_f32 v164, v164
  v_rcp_f32 v165, v165
  v_rcp_f32 v166, v166
  v_rcp_f32 v167, v167
  s_nop 0
  v_pk_mul_f32 v[160:161], v[160:161], v[164:165]
  v_pk_mul_f32 v[162:163], v[162:163], v[166:167]
  v_cvt_pk_bf16_f32 v40, v160, v161
  v_cvt_pk_bf16_f32 v41, v162, v163
  buffer_store_dwordx2 v[40:41], v8, s[16:19], 0 offen offset:1024 sc1
gemm1_kernel_done:
  s_endpgm
.globl gemm2_kernel
.p2align 8
.type gemm2_kernel,@function
gemm2_kernel:
  s_cmp_ge_u32 s2, 256
  s_cbranch_scc1 gemm2_kernel_done

  s_load_dwordx2 s[4:5], s[0:1], 80
  s_load_dwordx2 s[6:7], s[0:1], 112
  v_lshrrev_b32 v1, 6, v0
  s_and_b32 s32, s2, 7
  s_lshr_b32 s33, s2, 3
  v_readfirstlane_b32 s3, v1
  v_and_b32 v1, 63, v0
  s_add_u32 s34, s33, 0
  s_and_b32 s34, s34, 7
  s_lshr_b32 s39, s33, 3
  s_and_b32 s35, s32, 1
  s_lshl_b32 s35, s35, 2
  s_add_u32 s33, s39, s35
  s_lshr_b32 s32, s32, 1
  s_mul_i32 s32, s32, 8
  s_add_u32 s32, s32, s34
  s_and_b32 s32, s2, 7
  s_lshl_b32 s32, s32, 2
  s_bfe_u32 s36, s2, 0x20003
  s_add_u32 s32, s32, s36
  s_lshr_b32 s33, s2, 5
  s_mul_i32 s40, s33, 276608
  s_add_u32 s40, s40, 16777216
  s_cmp_lt_u32 s3, 4
  s_cbranch_scc1 gemm2_kernel_consumer
  s_cmp_eq_u32 s3, 7
  s_cbranch_scc1 gemm2_kernel_toucher
  s_lshl_b32 s29, s39, 1
  s_add_u32 s29, s29, s34
  s_and_b32 s29, s29, 7
  s_lshl_b32 s29, s29, 1
  s_and_b32 s36, s2, 0
  s_add_u32 s29, s29, s36
  s_mul_i32 s29, s29, 0
  s_lshr_b32 s29, s29, 4

  v_lshlrev_b32 v2, 4, v1
  v_lshrrev_b32 v10, 3, v1
  v_mul_u32_u24 v10, 4096, v10
  v_and_b32 v11, 7, v1
  v_bfe_u32 v12, v1, 4, 1
  v_lshlrev_b32 v12, 1, v12
  v_xor_b32 v11, v11, v12
  s_lshl_b32 s36, s32, 7
  v_add_u32 v10, s36, v10
  v_lshl_add_u32 v3, v11, 4, v10
  v_xor_b32 v11, 4, v11
  v_lshl_add_u32 v4, v11, 4, v10
  v_add_u32 v4, 31744, v4
  v_add_u32 v5, 63488, v3
  v_add_u32 v6, 63488, v4
  s_waitcnt lgkmcnt(0)
  s_mov_b32 s8, s4
  s_mov_b32 s9, s5
  s_mov_b32 s10, 7077888
  s_mov_b32 s11, 0x00020000
  s_add_u32 s12, s6, s40
  s_addc_u32 s13, s7, 0
  s_mov_b32 s14, 276480
  s_mov_b32 s15, 0x00020000
  s_cmp_lg_u32 s3, 4
  s_cbranch_scc1 gemm2_kernel_ld1
  s_mul_i32 s24, s29, 10240
  s_mul_i32 s25, s29, 10240
  s_add_u32 s24, s24, 0
  s_add_u32 s25, s25, 4096
  s_mov_b32 s26, 0
  s_mov_b32 s28, 4
gemm2_kernel_ld0_pro:
  s_add_u32 m0, s26, 0
  s_add_u32 s27, s26, 18432
  buffer_load_dwordx4 v2, s[12:15], s24 offen offset:0  lds
  buffer_load_dwordx4 v2, s[12:15], s24 offen offset:1024  lds
  buffer_load_dwordx4 v2, s[12:15], s24 offen offset:2048  lds
  buffer_load_dwordx4 v2, s[12:15], s24 offen offset:3072  lds
  s_add_u32 m0, s26, 4096
  s_cmp_ge_u32 s27, 92160
  buffer_load_dwordx4 v2, s[12:15], s25 offen offset:0  lds
  buffer_load_dwordx4 v2, s[12:15], s25 offen offset:1024  lds
  s_cselect_b32 s26, 0, s27
  s_add_u32 s24, s24, 10240
  s_add_u32 s25, s25, 10240
  s_add_u32 s29, s29, 1
  s_cmp_eq_u32 s29, 27
  s_cselect_b32 s29, 0, s29
  s_cselect_b32 s24, 0, s24
  s_cselect_b32 s25, 4096, s25
  s_sub_u32 s28, s28, 1
  s_cmp_lg_u32 s28, 0
  s_cbranch_scc1 gemm2_kernel_ld0_pro
  s_mov_b32 s28, 23
gemm2_kernel_ld0_loop:
  s_waitcnt vmcnt(18)
  s_barrier
  s_add_u32 m0, s26, 0
  s_add_u32 s27, s26, 18432
  buffer_load_dwordx4 v2, s[12:15], s24 offen offset:0  lds
  buffer_load_dwordx4 v2, s[12:15], s24 offen offset:1024  lds
  buffer_load_dwordx4 v2, s[12:15], s24 offen offset:2048  lds
  buffer_load_dwordx4 v2, s[12:15], s24 offen offset:3072  lds
  s_add_u32 m0, s26, 4096
  s_cmp_ge_u32 s27, 92160
  buffer_load_dwordx4 v2, s[12:15], s25 offen offset:0  lds
  buffer_load_dwordx4 v2, s[12:15], s25 offen offset:1024  lds
  s_cselect_b32 s26, 0, s27
  s_add_u32 s24, s24, 10240
  s_add_u32 s25, s25, 10240
  s_add_u32 s29, s29, 1
  s_cmp_eq_u32 s29, 27
  s_cselect_b32 s29, 0, s29
  s_cselect_b32 s24, 0, s24
  s_cselect_b32 s25, 4096, s25
  s_sub_u32 s28, s28, 1
  s_cmp_lg_u32 s28, 0
  s_cbranch_scc1 gemm2_kernel_ld0_loop
  s_waitcnt vmcnt(18)
  s_barrier
  s_waitcnt vmcnt(12)
  s_barrier
  s_waitcnt vmcnt(6)
  s_barrier
  s_waitcnt vmcnt(0)
  s_barrier
  s_endpgm
gemm2_kernel_ld1:
  s_cmp_lg_u32 s3, 5
  s_cbranch_scc1 gemm2_kernel_ld2
  s_mul_i32 s24, s29, 10240
  s_mul_i32 s25, s29, 262144
  s_add_u32 s24, s24, 6144
  s_add_u32 s25, s25, 0
  s_mov_b32 s26, 0
  s_mov_b32 s28, 4
gemm2_kernel_ld1_pro:
  s_add_u32 m0, s26, 6144
  s_add_u32 s27, s26, 18432
  buffer_load_dwordx4 v2, s[12:15], s24 offen offset:0  lds
  buffer_load_dwordx4 v2, s[12:15], s24 offen offset:1024  lds
  buffer_load_dwordx4 v2, s[12:15], s24 offen offset:2048  lds
  buffer_load_dwordx4 v2, s[12:15], s24 offen offset:3072  lds
  s_add_u32 m0, s26, 10240
  s_cmp_ge_u32 s27, 92160
  buffer_load_dwordx4 v3, s[8:11], s25 offen offset:0  lds
  buffer_load_dwordx4 v4, s[8:11], s25 offen offset:1024  lds
  s_cselect_b32 s26, 0, s27
  s_add_u32 s24, s24, 10240
  s_add_u32 s25, s25, 262144
  s_add_u32 s29, s29, 1
  s_cmp_eq_u32 s29, 27
  s_cselect_b32 s29, 0, s29
  s_cselect_b32 s24, 6144, s24
  s_cselect_b32 s25, 0, s25
  s_sub_u32 s28, s28, 1
  s_cmp_lg_u32 s28, 0
  s_cbranch_scc1 gemm2_kernel_ld1_pro
  s_mov_b32 s28, 23
gemm2_kernel_ld1_loop:
  s_waitcnt vmcnt(18)
  s_barrier
  s_add_u32 m0, s26, 6144
  s_add_u32 s27, s26, 18432
  buffer_load_dwordx4 v2, s[12:15], s24 offen offset:0  lds
  buffer_load_dwordx4 v2, s[12:15], s24 offen offset:1024  lds
  buffer_load_dwordx4 v2, s[12:15], s24 offen offset:2048  lds
  buffer_load_dwordx4 v2, s[12:15], s24 offen offset:3072  lds
  s_add_u32 m0, s26, 10240
  s_cmp_ge_u32 s27, 92160
  buffer_load_dwordx4 v3, s[8:11], s25 offen offset:0  lds
  buffer_load_dwordx4 v4, s[8:11], s25 offen offset:1024  lds
  s_cselect_b32 s26, 0, s27
  s_add_u32 s24, s24, 10240
  s_add_u32 s25, s25, 262144
  s_add_u32 s29, s29, 1
  s_cmp_eq_u32 s29, 27
  s_cselect_b32 s29, 0, s29
  s_cselect_b32 s24, 6144, s24
  s_cselect_b32 s25, 0, s25
  s_sub_u32 s28, s28, 1
  s_cmp_lg_u32 s28, 0
  s_cbranch_scc1 gemm2_kernel_ld1_loop
  s_waitcnt vmcnt(18)
  s_barrier
  s_waitcnt vmcnt(12)
  s_barrier
  s_waitcnt vmcnt(6)
  s_barrier
  s_waitcnt vmcnt(0)
  s_barrier
  s_endpgm
gemm2_kernel_ld2:
  s_mul_i32 s24, s29, 262144
  s_mul_i32 s25, s29, 262144
  s_add_u32 s24, s24, 65536
  s_add_u32 s25, s25, 196608
  s_mov_b32 s26, 0
  s_mov_b32 s28, 4
gemm2_kernel_ld2_pro:
  s_add_u32 m0, s26, 12288
  s_add_u32 s27, s26, 18432
  buffer_load_dwordx4 v3, s[8:11], s24 offen offset:0  lds
  buffer_load_dwordx4 v4, s[8:11], s24 offen offset:1024  lds
  buffer_load_dwordx4 v5, s[8:11], s24 offen offset:2048  lds
  buffer_load_dwordx4 v6, s[8:11], s24 offen offset:3072  lds
  s_add_u32 m0, s26, 16384
  s_cmp_ge_u32 s27, 92160
  buffer_load_dwordx4 v3, s[8:11], s25 offen offset:0  lds
  buffer_load_dwordx4 v4, s[8:11], s25 offen offset:1024  lds
  s_cselect_b32 s26, 0, s27
  s_add_u32 s24, s24, 262144
  s_add_u32 s25, s25, 262144
  s_add_u32 s29, s29, 1
  s_cmp_eq_u32 s29, 27
  s_cselect_b32 s29, 0, s29
  s_cselect_b32 s24, 65536, s24
  s_cselect_b32 s25, 196608, s25
  s_sub_u32 s28, s28, 1
  s_cmp_lg_u32 s28, 0
  s_cbranch_scc1 gemm2_kernel_ld2_pro
  s_mov_b32 s28, 23
gemm2_kernel_ld2_loop:
  s_waitcnt vmcnt(18)
  s_barrier
  s_add_u32 m0, s26, 12288
  s_add_u32 s27, s26, 18432
  buffer_load_dwordx4 v3, s[8:11], s24 offen offset:0  lds
  buffer_load_dwordx4 v4, s[8:11], s24 offen offset:1024  lds
  buffer_load_dwordx4 v5, s[8:11], s24 offen offset:2048  lds
  buffer_load_dwordx4 v6, s[8:11], s24 offen offset:3072  lds
  s_add_u32 m0, s26, 16384
  s_cmp_ge_u32 s27, 92160
  buffer_load_dwordx4 v3, s[8:11], s25 offen offset:0  lds
  buffer_load_dwordx4 v4, s[8:11], s25 offen offset:1024  lds
  s_cselect_b32 s26, 0, s27
  s_add_u32 s24, s24, 262144
  s_add_u32 s25, s25, 262144
  s_add_u32 s29, s29, 1
  s_cmp_eq_u32 s29, 27
  s_cselect_b32 s29, 0, s29
  s_cselect_b32 s24, 65536, s24
  s_cselect_b32 s25, 196608, s25
  s_sub_u32 s28, s28, 1
  s_cmp_lg_u32 s28, 0
  s_cbranch_scc1 gemm2_kernel_ld2_loop
  s_waitcnt vmcnt(18)
  s_barrier
  s_waitcnt vmcnt(12)
  s_barrier
  s_waitcnt vmcnt(6)
  s_barrier
  s_waitcnt vmcnt(0)
  s_barrier
  s_endpgm
gemm2_kernel_toucher:
  s_endpgm
gemm2_kernel_consumer:
  s_load_dwordx2 s[28:29], s[0:1], 88
  s_load_dwordx2 s[30:31], s[0:1], 96
  s_mov_b32 s38, 0
  v_lshrrev_b32 v12, 4, v1
  s_lshl_b32 s36, s38, 2
  v_add_u32 v13, s36, v12
  v_mul_u32_u24 v13, 1280, v13
  v_and_b32 v14, 15, v1
  v_lshl_add_u32 v2, v14, 4, v13
  v_bfe_u32 v13, v1, 2, 2
  v_lshl_add_u32 v14, v12, 3, v13
  v_lshlrev_b32 v14, 7, v14
  v_and_b32 v15, 3, v1
  v_lshl_add_u32 v14, v15, 3, v14
  s_lshl_b32 s36, s38, 12
  s_add_u32 s36, s36, 10240
  v_add_u32 v14, s36, v14
  v_lshrrev_b32 v13, 1, v13
  v_and_b32 v12, 1, v12
  v_lshl_or_b32 v13, v12, 1, v13
  v_xor_b32 v15, s3, v13
  v_lshl_add_u32 v3, v15, 5, v14
  v_add_u32 v14, 0x1000, v14
  v_lshl_add_u32 v4, v15, 5, v14
  s_waitcnt lgkmcnt(0)
  s_lshl_b32 s36, s34, 8
  v_add_u32 v5, s36, v0
  v_lshlrev_b32 v5, 7, v5
  s_add_u32 s12, s6, s40
  s_addc_u32 s13, s7, 0
  s_mov_b32 s14, 276480
  s_mov_b32 s15, 0x00020000
  s_lshl_b32 s36, s39, 8
  v_add_u32 v6, s36, v0
  v_mul_u32_u24 v6, 4096, v6
  s_lshl_b32 s36, s32, 7
  v_add_u32 v6, s36, v6
  s_mov_b32 s8, s4
  s_mov_b32 s9, s5
  s_mov_b32 s10, 7077888
  s_mov_b32 s11, 0x00020000
  s_mov_b32 s16, s30
  s_mov_b32 s17, s31
  s_mov_b32 s18, 2621440
  s_mov_b32 s19, 0x00020000
  s_add_u32 s20, s6, 8388608
  s_addc_u32 s21, s7, 0
  s_mov_b32 s22, 2621440
  s_mov_b32 s23, 0x00020000
  s_mov_b32 s44, s28
  s_mov_b32 s45, s29
  s_mov_b32 s46, 4096
  s_mov_b32 s47, 0x00020000
  v_and_b32 v12, 15, v1
  s_lshl_b32 s36, s32, 6
  s_lshl_b32 s37, s3, 4
  s_add_u32 s36, s36, s37
  v_add_u32 v12, s36, v12
  v_lshlrev_b32 v13, 1, v12
  buffer_load_ushort v26, v13, s[44:47], 0 offen
  v_mul_u32_u24 v12, 1280, v12
  s_mul_i32 s36, s33, 160
  v_add_u32 v12, s36, v12
  v_lshrrev_b32 v13, 4, v1
  v_lshl_add_u32 v8, v13, 3, v12
  v_and_b32 v14, 1, v13
  v_lshl_add_u32 v12, v14, 5, v12
  v_lshrrev_b32 v13, 1, v13
  v_lshl_add_u32 v7, v13, 4, v12
  buffer_load_dwordx4 v[16:19], v7, s[20:23], 0 offen
  buffer_load_dwordx4 v[20:23], v7, s[20:23], 0 offen offset:64
  buffer_load_dwordx2 v[24:25], v8, s[20:23], 0 offen offset:128
  v_pk_mov_b32 v[128:129], 0, 0
  v_pk_mov_b32 v[130:131], 0, 0
  v_pk_mov_b32 v[132:133], 0, 0
  v_pk_mov_b32 v[134:135], 0, 0
  v_pk_mov_b32 v[136:137], 0, 0
  v_pk_mov_b32 v[138:139], 0, 0
  v_pk_mov_b32 v[140:141], 0, 0
  v_pk_mov_b32 v[142:143], 0, 0
  v_pk_mov_b32 v[144:145], 0, 0
  v_pk_mov_b32 v[146:147], 0, 0
  v_pk_mov_b32 v[148:149], 0, 0
  v_pk_mov_b32 v[150:151], 0, 0
  v_pk_mov_b32 v[152:153], 0, 0
  v_pk_mov_b32 v[154:155], 0, 0
  v_pk_mov_b32 v[156:157], 0, 0
  v_pk_mov_b32 v[158:159], 0, 0
  v_pk_mov_b32 v[160:161], 0, 0
  v_pk_mov_b32 v[162:163], 0, 0
  v_pk_mov_b32 v[164:165], 0, 0
  v_pk_mov_b32 v[166:167], 0, 0
  s_mov_b32 s26, 18432
  s_mul_i32 s36, s3, 5120
  s_add_u32 s36, s36, 55296
  v_lshlrev_b32 v12, 4, v1
  v_add_u32 v28, s36, v12
  s_xor_b32 s36, s3, 1
  s_mul_i32 s36, s36, 5120
  s_add_u32 s36, s36, 55296
  v_add_u32 v29, s36, v12
  s_barrier
  ds_read_b64_tr_b16 v[112:113], v3 offset:0
  ds_read_b64_tr_b16 v[114:115], v3 offset:512
  ds_read_b128 v[32:35], v2 offset:0
  ds_read_b128 v[36:39], v2 offset:256
  ds_read_b128 v[40:43], v2 offset:512
  ds_read_b128 v[44:47], v2 offset:768
  ds_read_b128 v[48:51], v2 offset:1024
  ds_read_b64_tr_b16 v[116:117], v4 offset:0
  ds_read_b64_tr_b16 v[118:119], v4 offset:512
  ds_read_b128 v[52:55], v2 offset:5120
  ds_read_b128 v[56:59], v2 offset:5376
  ds_read_b128 v[60:63], v2 offset:5632
  ds_read_b128 v[64:67], v2 offset:5888
  ds_read_b128 v[68:71], v2 offset:6144
  v_add_u32 v9, s26, v2
  v_add_u32 v10, s26, v3
  v_add_u32 v11, s26, v4
  s_add_u32 s26, s26, 18432
  s_cmp_ge_u32 s26, 92160
  s_cselect_b32 s26, 0, s26
  s_waitcnt lgkmcnt(0)
  s_mov_b32 s27, 13
gemm2_kernel_cloop:
  s_barrier
  ds_read_b64_tr_b16 v[120:121], v10 offset:0
  ds_read_b64_tr_b16 v[122:123], v10 offset:512
  v_mfma_f32_16x16x32_bf16 v[128:131], v[32:35], v[112:115], v[128:131]
  ds_read_b128 v[72:75], v9 offset:0
  ds_read_b128 v[76:79], v9 offset:256
  v_mfma_f32_16x16x32_bf16 v[136:139], v[36:39], v[112:115], v[136:139]
  ds_read_b128 v[80:83], v9 offset:512
  ds_read_b128 v[84:87], v9 offset:768
  v_mfma_f32_16x16x32_bf16 v[144:147], v[40:43], v[112:115], v[144:147]
  ds_read_b128 v[88:91], v9 offset:1024
  ds_read_b64_tr_b16 v[124:125], v11 offset:0
  v_mfma_f32_16x16x32_bf16 v[152:155], v[44:47], v[112:115], v[152:155]
  ds_read_b64_tr_b16 v[126:127], v11 offset:512
  v_mfma_f32_16x16x32_bf16 v[160:163], v[48:51], v[112:115], v[160:163]
  ds_read_b128 v[92:95], v9 offset:5120
  v_mfma_f32_16x16x32_bf16 v[128:131], v[52:55], v[116:119], v[128:131]
  ds_read_b128 v[96:99], v9 offset:5376
  v_mfma_f32_16x16x32_bf16 v[136:139], v[56:59], v[116:119], v[136:139]
  ds_read_b128 v[100:103], v9 offset:5632
  v_mfma_f32_16x16x32_bf16 v[144:147], v[60:63], v[116:119], v[144:147]
  ds_read_b128 v[104:107], v9 offset:5888
  v_mfma_f32_16x16x32_bf16 v[152:155], v[64:67], v[116:119], v[152:155]
  ds_read_b128 v[108:111], v9 offset:6144
  v_mfma_f32_16x16x32_bf16 v[160:163], v[68:71], v[116:119], v[160:163]
  v_add_u32 v9, s26, v2
  v_add_u32 v10, s26, v3
  v_add_u32 v11, s26, v4
  s_add_u32 s26, s26, 18432
  s_cmp_ge_u32 s26, 92160
  s_cselect_b32 s26, 0, s26
  s_waitcnt lgkmcnt(0)
  s_barrier
  ds_read_b64_tr_b16 v[112:113], v10 offset:0
  ds_read_b64_tr_b16 v[114:115], v10 offset:512
  v_mfma_f32_16x16x32_bf16 v[128:131], v[72:75], v[120:123], v[128:131]
  ds_read_b128 v[32:35], v9 offset:0
  ds_read_b128 v[36:39], v9 offset:256
  v_mfma_f32_16x16x32_bf16 v[136:139], v[76:79], v[120:123], v[136:139]
  ds_read_b128 v[40:43], v9 offset:512
  ds_read_b128 v[44:47], v9 offset:768
  v_mfma_f32_16x16x32_bf16 v[144:147], v[80:83], v[120:123], v[144:147]
  ds_read_b128 v[48:51], v9 offset:1024
  ds_read_b64_tr_b16 v[116:117], v11 offset:0
  v_mfma_f32_16x16x32_bf16 v[152:155], v[84:87], v[120:123], v[152:155]
  ds_read_b64_tr_b16 v[118:119], v11 offset:512
  v_mfma_f32_16x16x32_bf16 v[160:163], v[88:91], v[120:123], v[160:163]
  ds_read_b128 v[52:55], v9 offset:5120
  v_mfma_f32_16x16x32_bf16 v[128:131], v[92:95], v[124:127], v[128:131]
  ds_read_b128 v[56:59], v9 offset:5376
  v_mfma_f32_16x16x32_bf16 v[136:139], v[96:99], v[124:127], v[136:139]
  ds_read_b128 v[60:63], v9 offset:5632
  v_mfma_f32_16x16x32_bf16 v[144:147], v[100:103], v[124:127], v[144:147]
  ds_read_b128 v[64:67], v9 offset:5888
  v_mfma_f32_16x16x32_bf16 v[152:155], v[104:107], v[124:127], v[152:155]
  ds_read_b128 v[68:71], v9 offset:6144
  v_mfma_f32_16x16x32_bf16 v[160:163], v[108:111], v[124:127], v[160:163]
  v_add_u32 v9, s26, v2
  v_add_u32 v10, s26, v3
  v_add_u32 v11, s26, v4
  s_add_u32 s26, s26, 18432
  s_cmp_ge_u32 s26, 92160
  s_cselect_b32 s26, 0, s26
  s_waitcnt lgkmcnt(0)
  s_sub_u32 s27, s27, 1
  s_cmp_lg_u32 s27, 0
  s_cbranch_scc1 gemm2_kernel_cloop
  v_mfma_f32_16x16x32_bf16 v[128:131], v[32:35], v[112:115], v[128:131]
  v_mfma_f32_16x16x32_bf16 v[136:139], v[36:39], v[112:115], v[136:139]
  v_mfma_f32_16x16x32_bf16 v[144:147], v[40:43], v[112:115], v[144:147]
  v_mfma_f32_16x16x32_bf16 v[152:155], v[44:47], v[112:115], v[152:155]
  v_mfma_f32_16x16x32_bf16 v[160:163], v[48:51], v[112:115], v[160:163]
  v_mfma_f32_16x16x32_bf16 v[128:131], v[52:55], v[116:119], v[128:131]
  v_mfma_f32_16x16x32_bf16 v[136:139], v[56:59], v[116:119], v[136:139]
  v_mfma_f32_16x16x32_bf16 v[144:147], v[60:63], v[116:119], v[144:147]
  v_mfma_f32_16x16x32_bf16 v[152:155], v[64:67], v[116:119], v[152:155]
  v_mfma_f32_16x16x32_bf16 v[160:163], v[68:71], v[116:119], v[160:163]
  s_waitcnt vmcnt(0)
  v_lshlrev_b32 v26, 16, v26
  v_lshlrev_b32 v32, 16, v16
  v_and_b32 v33, 0xffff0000, v16
  v_lshlrev_b32 v34, 16, v17
  v_and_b32 v35, 0xffff0000, v17
  v_lshlrev_b32 v36, 16, v18
  v_and_b32 v37, 0xffff0000, v18
  v_lshlrev_b32 v38, 16, v19
  v_and_b32 v39, 0xffff0000, v19
  v_lshlrev_b32 v40, 16, v20
  v_and_b32 v41, 0xffff0000, v20
  v_lshlrev_b32 v42, 16, v21
  v_and_b32 v43, 0xffff0000, v21
  v_lshlrev_b32 v44, 16, v22
  v_and_b32 v45, 0xffff0000, v22
  v_lshlrev_b32 v46, 16, v23
  v_and_b32 v47, 0xffff0000, v23
  v_lshlrev_b32 v48, 16, v24
  v_and_b32 v49, 0xffff0000, v24
  v_lshlrev_b32 v50, 16, v25
  v_and_b32 v51, 0xffff0000, v25
  s_nop 3
  v_cvt_pk_bf16_f32 v129, v128, v129
  v_cvt_pk_bf16_f32 v131, v130, v131
  v_lshlrev_b32 v128, 16, v129
  v_and_b32 v129, 0xffff0000, v129
  v_lshlrev_b32 v130, 16, v131
  v_and_b32 v131, 0xffff0000, v131
  v_pk_add_f32 v[128:129], v[128:129], v[26:27] op_sel_hi:[1,0]
  v_pk_add_f32 v[130:131], v[130:131], v[26:27] op_sel_hi:[1,0]
  v_cvt_pk_bf16_f32 v129, v128, v129
  v_cvt_pk_bf16_f32 v131, v130, v131
  v_lshlrev_b32 v128, 16, v129
  v_and_b32 v129, 0xffff0000, v129
  v_lshlrev_b32 v130, 16, v131
  v_and_b32 v131, 0xffff0000, v131
  v_cvt_pk_bf16_f32 v137, v136, v137
  v_cvt_pk_bf16_f32 v139, v138, v139
  v_lshlrev_b32 v136, 16, v137
  v_and_b32 v137, 0xffff0000, v137
  v_lshlrev_b32 v138, 16, v139
  v_and_b32 v139, 0xffff0000, v139
  v_pk_add_f32 v[136:137], v[136:137], v[26:27] op_sel_hi:[1,0]
  v_pk_add_f32 v[138:139], v[138:139], v[26:27] op_sel_hi:[1,0]
  v_cvt_pk_bf16_f32 v137, v136, v137
  v_cvt_pk_bf16_f32 v139, v138, v139
  v_lshlrev_b32 v136, 16, v137
  v_and_b32 v137, 0xffff0000, v137
  v_lshlrev_b32 v138, 16, v139
  v_and_b32 v139, 0xffff0000, v139
  s_nop 1
  v_permlane16_swap_b32 v128, v136
  v_permlane16_swap_b32 v129, v137
  v_permlane16_swap_b32 v130, v138
  v_permlane16_swap_b32 v131, v139
  s_nop 0
  v_pk_add_f32 v[32:33], v[32:33], v[128:129]
  v_pk_add_f32 v[34:35], v[34:35], v[130:131]
  v_pk_add_f32 v[36:37], v[36:37], v[136:137]
  v_pk_add_f32 v[38:39], v[38:39], v[138:139]
  v_cvt_pk_bf16_f32 v112, v32, v33
  v_cvt_pk_bf16_f32 v113, v34, v35
  v_cvt_pk_bf16_f32 v114, v36, v37
  v_cvt_pk_bf16_f32 v115, v38, v39
  buffer_store_dwordx4 v[112:115], v7, s[16:19], 0 offen offset:0
  v_cvt_pk_bf16_f32 v145, v144, v145
  v_cvt_pk_bf16_f32 v147, v146, v147
  v_lshlrev_b32 v144, 16, v145
  v_and_b32 v145, 0xffff0000, v145
  v_lshlrev_b32 v146, 16, v147
  v_and_b32 v147, 0xffff0000, v147
  v_pk_add_f32 v[144:145], v[144:145], v[26:27] op_sel_hi:[1,0]
  v_pk_add_f32 v[146:147], v[146:147], v[26:27] op_sel_hi:[1,0]
  v_cvt_pk_bf16_f32 v145, v144, v145
  v_cvt_pk_bf16_f32 v147, v146, v147
  v_lshlrev_b32 v144, 16, v145
  v_and_b32 v145, 0xffff0000, v145
  v_lshlrev_b32 v146, 16, v147
  v_and_b32 v147, 0xffff0000, v147
  v_cvt_pk_bf16_f32 v153, v152, v153
  v_cvt_pk_bf16_f32 v155, v154, v155
  v_lshlrev_b32 v152, 16, v153
  v_and_b32 v153, 0xffff0000, v153
  v_lshlrev_b32 v154, 16, v155
  v_and_b32 v155, 0xffff0000, v155
  v_pk_add_f32 v[152:153], v[152:153], v[26:27] op_sel_hi:[1,0]
  v_pk_add_f32 v[154:155], v[154:155], v[26:27] op_sel_hi:[1,0]
  v_cvt_pk_bf16_f32 v153, v152, v153
  v_cvt_pk_bf16_f32 v155, v154, v155
  v_lshlrev_b32 v152, 16, v153
  v_and_b32 v153, 0xffff0000, v153
  v_lshlrev_b32 v154, 16, v155
  v_and_b32 v155, 0xffff0000, v155
  s_nop 1
  v_permlane16_swap_b32 v144, v152
  v_permlane16_swap_b32 v145, v153
  v_permlane16_swap_b32 v146, v154
  v_permlane16_swap_b32 v147, v155
  s_nop 0
  v_pk_add_f32 v[40:41], v[40:41], v[144:145]
  v_pk_add_f32 v[42:43], v[42:43], v[146:147]
  v_pk_add_f32 v[44:45], v[44:45], v[152:153]
  v_pk_add_f32 v[46:47], v[46:47], v[154:155]
  v_cvt_pk_bf16_f32 v116, v40, v41
  v_cvt_pk_bf16_f32 v117, v42, v43
  v_cvt_pk_bf16_f32 v118, v44, v45
  v_cvt_pk_bf16_f32 v119, v46, v47
  buffer_store_dwordx4 v[116:119], v7, s[16:19], 0 offen offset:64
  v_cvt_pk_bf16_f32 v161, v160, v161
  v_cvt_pk_bf16_f32 v163, v162, v163
  v_lshlrev_b32 v160, 16, v161
  v_and_b32 v161, 0xffff0000, v161
  v_lshlrev_b32 v162, 16, v163
  v_and_b32 v163, 0xffff0000, v163
  v_pk_add_f32 v[160:161], v[160:161], v[26:27] op_sel_hi:[1,0]
  v_pk_add_f32 v[162:163], v[162:163], v[26:27] op_sel_hi:[1,0]
  v_cvt_pk_bf16_f32 v161, v160, v161
  v_cvt_pk_bf16_f32 v163, v162, v163
  v_lshlrev_b32 v160, 16, v161
  v_and_b32 v161, 0xffff0000, v161
  v_lshlrev_b32 v162, 16, v163
  v_and_b32 v163, 0xffff0000, v163
  v_pk_add_f32 v[48:49], v[48:49], v[160:161]
  v_pk_add_f32 v[50:51], v[50:51], v[162:163]
  v_cvt_pk_bf16_f32 v120, v48, v49
  v_cvt_pk_bf16_f32 v121, v50, v51
  buffer_store_dwordx2 v[120:121], v8, s[16:19], 0 offen offset:128
gemm2_kernel_done:
  s_endpgm
code_pf_end:
.section .rodata,"a"
.p2align 6
.amdhsa_kernel k12_kernel
  .amdhsa_next_free_vgpr 128
  .amdhsa_next_free_sgpr 56
  .amdhsa_accum_offset 128
  .amdhsa_group_segment_fixed_size 0
  .amdhsa_kernarg_size 120
  .amdhsa_user_sgpr_count 2
  .amdhsa_user_sgpr_kernarg_segment_ptr 1
  .amdhsa_system_sgpr_workgroup_id_x 1
.end_amdhsa_kernel
.p2align 6
.p2align 4
.type kimg_idx,@object
kimg_idx:
  .short 176, 176, 176, 176, 176, 176, 176, 176, 176, 176, 176, 176, 176, 176, 176, 176
  .short 176, 176, 176, 176, 176, 176, 176, 176, 176, 176, 176, 176, 176, 176, 176, 176
  .short 3044, 2936, 2932, 2928, 2924, 2920, 2916, 2912, 2748, 2744, 2740, 2736, 2732, 2728, 2724, 2720
  .short 2556, 2552, 2548, 2544, 2540, 2536, 2532, 2528, 2364, 2360, 2356, 2352, 2348, 2344, 2340, 2336
  .short 2172, 2168, 2164, 2160, 2156, 2152, 2148, 2144, 1980, 1976, 1972, 1968, 1964, 1960, 1956, 1952
  .short 1788, 1784, 1780, 1776, 1772, 1768, 1764, 1760, 1596, 1592, 1588, 1584, 1580, 1576, 1572, 1568
  .short 1404, 1400, 1396, 1392, 1388, 1384, 1380, 1376, 1212, 1208, 1204, 1200, 1196, 1192, 1188, 1184
  .short 1020, 1016, 1012, 1008, 1004, 1000, 996, 992, 828, 824, 820, 816, 812, 808, 804, 800
  .short 636, 632, 628, 624, 620, 616, 612, 608, 444, 440, 436, 432, 428, 424, 420, 416
  .short 252, 248, 244, 240, 236, 232, 228, 224, 60, 56, 52, 48, 44, 40, 36, 32
  .short 2908, 2904, 2900, 2896, 2892, 2888, 2884, 2880, 2716, 2712, 2708, 2704, 2700, 2696, 2692, 2688
  .short 2524, 2520, 2516, 2512, 2508, 2504, 2500, 2496, 2332, 2328, 2324, 2320, 2316, 2312, 2308, 2304
  .short 2140, 2136, 2132, 2128, 2124, 2120, 2116, 2112, 1948, 1944, 1940, 1936, 1932, 1928, 1924, 1920
  .short 1756, 1752, 1748, 1744, 1740, 1736, 1732, 1728, 1564, 1560, 1556, 1552, 1548, 1544, 1540, 1536
  .short 1372, 1368, 1364, 1360, 1356, 1352, 1348, 1344, 1180, 1176, 1172, 1168, 1164, 1160, 1156, 1152
  .short 988, 984, 980, 976, 972, 968, 964, 960, 796, 792, 788, 784, 780, 776, 772, 768
  .short 604, 600, 596, 592, 588, 584, 580, 576, 412, 408, 404, 400, 396, 392, 388, 384
  .short 220, 216, 212, 208, 204, 200, 196, 192, 28, 24, 20, 16, 12, 8, 4, 0
  .short 176, 176, 176, 176, 176, 176, 176, 176, 176, 176, 176, 176, 176, 176, 176, 176
  .short 176, 176, 176, 176, 176, 176, 176, 176, 176, 176, 176, 176, 176, 176, 176, 176
  .short 176, 176, 172, 172, 176, 176, 176, 176, 176, 176, 176, 176, 176, 176, 176, 176
  .short 176, 176, 176, 176, 176, 176, 176, 176, 176, 176, 176, 176, 176, 176, 176, 176
  .short 176, 176, 176, 176, 176, 176, 176, 176, 176, 176, 176, 176, 176, 176, 176, 176
  .short 176, 176, 176, 176, 176, 176, 176, 176, 176, 176, 176, 176, 176, 176, 176, 3044
  .short 2936, 2932, 2928, 2924, 2920, 2916, 2912, 2748, 2744, 2740, 2736, 2732, 2728, 2724, 2720, 2556
  .short 2552, 2548, 2544, 2540, 2536, 2532, 2528, 2364, 2360, 2356, 2352, 2348, 2344, 2340, 2336, 2172
  .short 2168, 2164, 2160, 2156, 2152, 2148, 2144, 1980, 1976, 1972, 1968, 1964, 1960, 1956, 1952, 1788
  .short 1784, 1780, 1776, 1772, 1768, 1764, 1760, 1596, 1592, 1588, 1584, 1580, 1576, 1572, 1568, 1404
  .short 1400, 1396, 1392, 1388, 1384, 1380, 1376, 1212, 1208, 1204, 1200, 1196, 1192, 1188, 1184, 1020
  .short 1016, 1012, 1008, 1004, 1000, 996, 992, 828, 824, 820, 816, 812, 808, 804, 800, 636
  .short 632, 628, 624, 620, 616, 612, 608, 444, 440, 436, 432, 428, 424, 420, 416, 252
  .short 248, 244, 240, 236, 232, 228, 224, 60, 56, 52, 48, 44, 40, 36, 32, 2908
  .short 2904, 2900, 2896, 2892, 2888, 2884, 2880, 2716, 2712, 2708, 2704, 2700, 2696, 2692, 2688, 2524
  .short 2520, 2516, 2512, 2508, 2504, 2500, 2496, 2332, 2328, 2324, 2320, 2316, 2312, 2308, 2304, 2140
  .short 2136, 2132, 2128, 2124, 2120, 2116, 2112, 1948, 1944, 1940, 1936, 1932, 1928, 1924, 1920, 1756
  .short 1752, 1748, 1744, 1740, 1736, 1732, 1728, 1564, 1560, 1556, 1552, 1548, 1544, 1540, 1536, 1372
  .short 1368, 1364, 1360, 1356, 1352, 1348, 1344, 1180, 1176, 1172, 1168, 1164, 1160, 1156, 1152, 988
  .short 984, 980, 976, 972, 968, 964, 960, 796, 792, 788, 784, 780, 776, 772, 768, 604
  .short 600, 596, 592, 588, 584, 580, 576, 412, 408, 404, 400, 396, 392, 388, 384, 220
  .short 216, 212, 208, 204, 200, 196, 192, 28, 24, 20, 16, 12, 8, 4, 0, 176
  .short 176, 176, 176, 176, 176, 176, 176, 176, 176, 176, 176, 176, 176, 176, 176, 176
  .short 176, 176, 176, 176, 176, 176, 176, 176, 176, 176, 176, 176, 176, 176, 176, 176
  .short 176, 172, 172, 176, 176, 176, 176, 176, 176, 176, 176, 176, 176, 176, 176, 176
  .short 176, 176, 176, 176, 176, 176, 176, 176, 176, 176, 176, 176, 176, 176, 176, 176
  .short 176, 176, 176, 176, 176, 176, 176, 176, 176, 176, 176, 176, 176, 176, 176, 176
  .short 176, 176, 176, 176, 176, 176, 176, 176, 176, 176, 176, 176, 176, 176, 3044, 2936
  .short 2932, 2928, 2924, 2920, 2916, 2912, 2748, 2744, 2740, 2736, 2732, 2728, 2724, 2720, 2556, 2552
  .short 2548, 2544, 2540, 2536, 2532, 2528, 2364, 2360, 2356, 2352, 2348, 2344, 2340, 2336, 2172, 2168
  .short 2164, 2160, 2156, 2152, 2148, 2144, 1980, 1976, 1972, 1968, 1964, 1960, 1956, 1952, 1788, 1784
  .short 1780, 1776, 1772, 1768, 1764, 1760, 1596, 1592, 1588, 1584, 1580, 1576, 1572, 1568, 1404, 1400
  .short 1396, 1392, 1388, 1384, 1380, 1376, 1212, 1208, 1204, 1200, 1196, 1192, 1188, 1184, 1020, 1016
  .short 1012, 1008, 1004, 1000, 996, 992, 828, 824, 820, 816, 812, 808, 804, 800, 636, 632
  .short 628, 624, 620, 616, 612, 608, 444, 440, 436, 432, 428, 424, 420, 416, 252, 248
  .short 244, 240, 236, 232, 228, 224, 60, 56, 52, 48, 44, 40, 36, 32, 2908, 2904
  .short 2900, 2896, 2892, 2888, 2884, 2880, 2716, 2712, 2708, 2704, 2700, 2696, 2692, 2688, 2524, 2520
  .short 2516, 2512, 2508, 2504, 2500, 2496, 2332, 2328, 2324, 2320, 2316, 2312, 2308, 2304, 2140, 2136
  .short 2132, 2128, 2124, 2120, 2116, 2112, 1948, 1944, 1940, 1936, 1932, 1928, 1924, 1920, 1756, 1752
  .short 1748, 1744, 1740, 1736, 1732, 1728, 1564, 1560, 1556, 1552, 1548, 1544, 1540, 1536, 1372, 1368
  .short 1364, 1360, 1356, 1352, 1348, 1344, 1180, 1176, 1172, 1168, 1164, 1160, 1156, 1152, 988, 984
  .short 980, 976, 972, 968, 964, 960, 796, 792, 788, 784, 780, 776, 772, 768, 604, 600
  .short 596, 592, 588, 584, 580, 576, 412, 408, 404, 400, 396, 392, 388, 384, 220, 216
  .short 212, 208, 204, 200, 196, 192, 28, 24, 20, 16, 12, 8, 4, 0, 176, 176
  .short 176, 176, 176, 176, 176, 176, 176, 176, 176, 176, 176, 176, 176, 176, 176, 176
  .short 176, 176, 176, 176, 176, 176, 176, 176, 176, 176, 176, 176, 176, 176, 176, 176
  .short 172, 172, 176, 176, 176, 176, 176, 176, 176, 176, 176, 176, 176, 176, 176, 176
  .short 176, 176, 176, 176, 176, 176, 176, 176, 176, 176, 176, 176, 176, 176, 176, 176
  .short 176, 176, 176, 176, 176, 176, 176, 176, 176, 176, 176, 176, 176, 176, 176, 176
  .short 176, 176, 176, 176, 176, 176, 176, 176, 176, 176, 176, 176, 176, 3044, 2936, 2932
  .short 2928, 2924, 2920, 2916, 2912, 2748, 2744, 2740, 2736, 2732, 2728, 2724, 2720, 2556, 2552, 2548
  .short 2544, 2540, 2536, 2532, 2528, 2364, 2360, 2356, 2352, 2348, 2344, 2340, 2336, 2172, 2168, 2164
  .short 2160, 2156, 2152, 2148, 2144, 1980, 1976, 1972, 1968, 1964, 1960, 1956, 1952, 1788, 1784, 1780
  .short 1776, 1772, 1768, 1764, 1760, 1596, 1592, 1588, 1584, 1580, 1576, 1572, 1568, 1404, 1400, 1396
  .short 1392, 1388, 1384, 1380, 1376, 1212, 1208, 1204, 1200, 1196, 1192, 1188, 1184, 1020, 1016, 1012
  .short 1008, 1004, 1000, 996, 992, 828, 824, 820, 816, 812, 808, 804, 800, 636, 632, 628
  .short 624, 620, 616, 612, 608, 444, 440, 436, 432, 428, 424, 420, 416, 252, 248, 244
  .short 240, 236, 232, 228, 224, 60, 56, 52, 48, 44, 40, 36, 32, 2908, 2904, 2900
  .short 2896, 2892, 2888, 2884, 2880, 2716, 2712, 2708, 2704, 2700, 2696, 2692, 2688, 2524, 2520, 2516
  .short 2512, 2508, 2504, 2500, 2496, 2332, 2328, 2324, 2320, 2316, 2312, 2308, 2304, 2140, 2136, 2132
  .short 2128, 2124, 2120, 2116, 2112, 1948, 1944, 1940, 1936, 1932, 1928, 1924, 1920, 1756, 1752, 1748
  .short 1744, 1740, 1736, 1732, 1728, 1564, 1560, 1556, 1552, 1548, 1544, 1540, 1536, 1372, 1368, 1364
  .short 1360, 1356, 1352, 1348, 1344, 1180, 1176, 1172, 1168, 1164, 1160, 1156, 1152, 988, 984, 980
  .short 976, 972, 968, 964, 960, 796, 792, 788, 784, 780, 776, 772, 768, 604, 600, 596
  .short 592, 588, 584, 580, 576, 412, 408, 404, 400, 396, 392, 388, 384, 220, 216, 212
  .short 208, 204, 200, 196, 192, 28, 24, 20, 16, 12, 8, 4, 0, 176, 176, 176
  .short 176, 176, 176, 176, 176, 176, 176, 176, 176, 176, 176, 176, 176, 176, 176, 176
  .short 176, 176, 176, 176, 176, 176, 176, 176, 176, 176, 176, 176, 176, 176, 176, 172
  .short 172, 176, 176, 176, 176, 176, 176, 176, 176, 176, 176, 176, 176, 176, 176, 176
  .short 176, 176, 176, 176, 176, 176, 176, 176, 176, 176, 176, 176, 176, 176, 176, 176
  .short 176, 176, 176, 176, 176, 176, 176, 176, 176, 176, 176, 176, 176, 176, 176, 160
  .short 2844, 2460, 2076, 1692, 1308, 924, 540, 156, 2840, 2456, 2072, 1688, 1304, 920, 536, 152
  .short 2836, 2452, 2068, 1684, 1300, 916, 532, 148, 2832, 2448, 2064, 1680, 1296, 912, 528, 144
  .short 2828, 2444, 2060, 1676, 1292, 908, 524, 140, 2824, 2440, 2056, 1672, 1288, 904, 520, 136
  .short 2820, 2436, 2052, 1668, 1284, 900, 516, 132, 2816, 2432, 2048, 1664, 1280, 896, 512, 128
  .short 176, 176, 176, 176, 176, 176, 176, 176, 176, 176, 176, 176, 176, 176, 176, 176
  .short 176, 176, 176, 176, 176, 176, 176, 176, 176, 176, 176, 176, 176, 176, 176, 176
  .short 3036, 2652, 2268, 1884, 1500, 1116, 732, 348, 3032, 2648, 2264, 1880, 1496, 1112, 728, 344
  .short 3028, 2644, 2260, 1876, 1492, 1108, 724, 340, 3024, 2640, 2256, 1872, 1488, 1104, 720, 336
  .short 3020, 2636, 2252, 1868, 1484, 1100, 716, 332, 3016, 2632, 2248, 1864, 1480, 1096, 712, 328
  .short 3012, 2628, 2244, 1860, 1476, 1092, 708, 324, 3008, 2624, 2240, 1856, 1472, 1088, 704, 320
  .short 176, 176, 176, 176, 176, 176, 176, 176, 176, 176, 176, 176, 176, 176, 176, 176
  .short 176, 176, 176, 176, 176, 176, 176, 176, 176, 176, 176, 176, 176, 176, 176, 176
  .short 176, 176, 176, 176, 176, 176, 176, 176, 176, 176, 176, 176, 176, 176, 176, 176
  .short 176, 176, 176, 176, 176, 176, 176, 176, 176, 176, 176, 176, 176, 176, 160, 2844
  .short 2460, 2076, 1692, 1308, 924, 540, 156, 2840, 2456, 2072, 1688, 1304, 920, 536, 152, 2836
  .short 2452, 2068, 1684, 1300, 916, 532, 148, 2832, 2448, 2064, 1680, 1296, 912, 528, 144, 2828
  .short 2444, 2060, 1676, 1292, 908, 524, 140, 2824, 2440, 2056, 1672, 1288, 904, 520, 136, 2820
  .short 2436, 2052, 1668, 1284, 900, 516, 132, 2816, 2432, 2048, 1664, 1280, 896, 512, 128, 176
  .short 176, 176, 176, 176, 176, 176, 176, 176, 176, 176, 176, 176, 176, 176, 176, 176
  .short 176, 176, 176, 176, 176, 176, 176, 176, 176, 176, 176, 176, 176, 176, 176, 3036
  .short 2652, 2268, 1884, 1500, 1116, 732, 348, 3032, 2648, 2264, 1880, 1496, 1112, 728, 344, 3028
  .short 2644, 2260, 1876, 1492, 1108, 724, 340, 3024, 2640, 2256, 1872, 1488, 1104, 720, 336, 3020
  .short 2636, 2252, 1868, 1484, 1100, 716, 332, 3016, 2632, 2248, 1864, 1480, 1096, 712, 328, 3012
  .short 2628, 2244, 1860, 1476, 1092, 708, 324, 3008, 2624, 2240, 1856, 1472, 1088, 704, 320, 176
  .short 176, 176, 176, 176, 176, 176, 176, 176, 176, 176, 176, 176, 176, 176, 176, 176
  .short 176, 176, 176, 176, 176, 176, 176, 176, 176, 176, 176, 176, 176, 176, 176, 176
  .short 176, 176, 176, 176, 176, 176, 176, 176, 176, 176, 176, 176, 176, 176, 176, 176
  .short 176, 176, 176, 176, 176, 176, 176, 176, 176, 176, 176, 176, 176, 160, 2844, 2460
  .short 2076, 1692, 1308, 924, 540, 156, 2840, 2456, 2072, 1688, 1304, 920, 536, 152, 2836, 2452
  .short 2068, 1684, 1300, 916, 532, 148, 2832, 2448, 2064, 1680, 1296, 912, 528, 144, 2828, 2444
  .short 2060, 1676, 1292, 908, 524, 140, 2824, 2440, 2056, 1672, 1288, 904, 520, 136, 2820, 2436
  .short 2052, 1668, 1284, 900, 516, 132, 2816, 2432, 2048, 1664, 1280, 896, 512, 128, 176, 176
  .short 176, 176, 176, 176, 176, 176, 176, 176, 176, 176, 176, 176, 176, 176, 176, 176
  .short 176, 176, 176, 176, 176, 176, 176, 176, 176, 176, 176, 176, 176, 176, 3036, 2652
  .short 2268, 1884, 1500, 1116, 732, 348, 3032, 2648, 2264, 1880, 1496, 1112, 728, 344, 3028, 2644
  .short 2260, 1876, 1492, 1108, 724, 340, 3024, 2640, 2256, 1872, 1488, 1104, 720, 336, 3020, 2636
  .short 2252, 1868, 1484, 1100, 716, 332, 3016, 2632, 2248, 1864, 1480, 1096, 712, 328, 3012, 2628
  .short 2244, 1860, 1476, 1092, 708, 324, 3008, 2624, 2240, 1856, 1472, 1088, 704, 320, 176, 176
  .short 176, 176, 176, 176, 176, 176, 176, 176, 176, 176, 176, 176, 176, 176, 176, 176
  .short 176, 176, 176, 176, 176, 176, 176, 176, 176, 176, 176, 176, 176, 176, 176, 176
  .short 176, 176, 176, 176, 176, 176, 176, 176, 176, 176, 176, 176, 176, 176, 176, 176
  .short 176, 176, 176, 176, 176, 176, 176, 176, 176, 176, 176, 176, 160, 2844, 2460, 2076
  .short 1692, 1308, 924, 540, 156, 2840, 2456, 2072, 1688, 1304, 920, 536, 152, 2836, 2452, 2068
  .short 1684, 1300, 916, 532, 148, 2832, 2448, 2064, 1680, 1296, 912, 528, 144, 2828, 2444, 2060
  .short 1676, 1292, 908, 524, 140, 2824, 2440, 2056, 1672, 1288, 904, 520, 136, 2820, 2436, 2052
  .short 1668, 1284, 900, 516, 132, 2816, 2432, 2048, 1664, 1280, 896, 512, 128, 176, 176, 176
  .short 176, 176, 176, 176, 176, 176, 176, 176, 176, 176, 176, 176, 176, 176, 176, 176
  .short 176, 176, 176, 176, 176, 176, 176, 176, 176, 176, 176, 176, 176, 3036, 2652, 2268
  .short 1884, 1500, 1116, 732, 348, 3032, 2648, 2264, 1880, 1496, 1112, 728, 344, 3028, 2644, 2260
  .short 1876, 1492, 1108, 724, 340, 3024, 2640, 2256, 1872, 1488, 1104, 720, 336, 3020, 2636, 2252
  .short 1868, 1484, 1100, 716, 332, 3016, 2632, 2248, 1864, 1480, 1096, 712, 328, 3012, 2628, 2244
  .short 1860, 1476, 1092, 708, 324, 3008, 2624, 2240, 1856, 1472, 1088, 704, 320, 176, 176, 176
  .short 176, 176, 176, 176, 176, 176, 176, 176, 176, 176, 176, 176, 176, 176, 176, 176
  .short 176, 176, 176, 176, 176, 176, 176, 176, 176, 176, 176, 176, 176, 176, 176, 176
  .short 176, 176, 176, 176, 176, 176, 176, 176, 176, 176, 176, 176, 176, 176, 176, 176
  .short 176, 176, 176, 176, 176, 176, 176, 176, 176, 176, 176, 176, 176, 176, 176, 176
  .short 176, 176, 176, 176, 176, 176, 176, 176, 176, 176, 176, 176, 176, 176, 176, 3000
  .short 2808, 2616, 2424, 2232, 2040, 1848, 1656, 1464, 1272, 1080, 888, 696, 504, 312, 120, 2992
  .short 2800, 2608, 2416, 2224, 2032, 1840, 1648, 1456, 1264, 1072, 880, 688, 496, 304, 112, 2984
  .short 2792, 2600, 2408, 2216, 2024, 1832, 1640, 1448, 1256, 1064, 872, 680, 488, 296, 104, 2976
  .short 2784, 2592, 2400, 2208, 2016, 1824, 1632, 1440, 1248, 1056, 864, 672, 480, 288, 96, 176
  .short 176, 176, 176, 176, 176, 176, 176, 176, 176, 176, 176, 176, 176, 176, 176, 176
  .short 176, 176, 176, 176, 176, 176, 176, 176, 176, 176, 176, 176, 176, 176, 176, 176
  .short 176, 176, 176, 176, 176, 176, 176, 176, 176, 176, 176, 176, 176, 176, 176, 176
  .short 176, 176, 176, 176, 176, 176, 176, 176, 176, 176, 176, 176, 176, 176, 176, 3004
  .short 2812, 2620, 2428, 2236, 2044, 1852, 1660, 1468, 1276, 1084, 892, 700, 508, 316, 124, 2996
  .short 2804, 2612, 2420, 2228, 2036, 1844, 1652, 1460, 1268, 1076, 884, 692, 500, 308, 116, 2988
  .short 2796, 2604, 2412, 2220, 2028, 1836, 1644, 1452, 1260, 1068, 876, 684, 492, 300, 108, 2980
  .short 2788, 2596, 2404, 2212, 2020, 1828, 1636, 1444, 1252, 1060, 868, 676, 484, 292, 100, 176
  .short 176, 176, 176, 176, 176, 176, 176, 176, 176, 176, 176, 176, 176, 176, 176, 176
  .short 176, 176, 176, 176, 176, 176, 176, 176, 176, 176, 176, 176, 176, 176, 176, 176
  .short 176, 176, 176, 176, 176, 176, 176, 176, 176, 176, 176, 176, 176, 176, 176, 176
  .short 176, 176, 176, 176, 176, 176, 176, 176, 176, 176, 176, 176, 176, 176, 176, 176
  .short 176, 176, 176, 176, 176, 176, 176, 176, 176, 176, 176, 176, 176, 176, 176, 176
  .short 176, 176, 176, 176, 176, 176, 176, 176, 176, 176, 176, 176, 176, 3000, 2808, 2616
  .short 2424, 2232, 2040, 1848, 1656, 1464, 1272, 1080, 888, 696, 504, 312, 120, 2992, 2800, 2608
  .short 2416, 2224, 2032, 1840, 1648, 1456, 1264, 1072, 880, 688, 496, 304, 112, 2984, 2792, 2600
  .short 2408, 2216, 2024, 1832, 1640, 1448, 1256, 1064, 872, 680, 488, 296, 104, 2976, 2784, 2592
  .short 2400, 2208, 2016, 1824, 1632, 1440, 1248, 1056, 864, 672, 480, 288, 96, 176, 176, 176
  .short 176, 176, 176, 176, 176, 176, 176, 176, 176, 176, 176, 176, 176, 176, 176, 176
  .short 176, 176, 176, 176, 176, 176, 176, 176, 176, 176, 176, 176, 176, 176, 176, 176
  .short 176, 176, 176, 176, 176, 176, 176, 176, 176, 176, 176, 176, 176, 176, 176, 176
  .short 176, 176, 176, 176, 176, 176, 176, 176, 176, 176, 176, 176, 176, 3004, 2812, 2620
  .short 2428, 2236, 2044, 1852, 1660, 1468, 1276, 1084, 892, 700, 508, 316, 124, 2996, 2804, 2612
  .short 2420, 2228, 2036, 1844, 1652, 1460, 1268, 1076, 884, 692, 500, 308, 116, 2988, 2796, 2604
  .short 2412, 2220, 2028, 1836, 1644, 1452, 1260, 1068, 876, 684, 492, 300, 108, 2980, 2788, 2596
  .short 2404, 2212, 2020, 1828, 1636, 1444, 1252, 1060, 868, 676, 484, 292, 100, 176, 176, 176
  .short 176, 176, 176, 176, 176, 176, 176, 176, 176, 176, 176, 176, 176, 176, 176, 176
  .short 176, 176, 176, 176, 176, 176, 176, 176, 176, 176, 176, 176, 176, 176, 176, 176
  .short 176, 176, 176, 176, 176, 176, 176, 176, 176, 176, 176, 176, 176, 176, 176, 176
  .short 176, 176, 176, 176, 176, 176, 176, 176, 176, 176, 176, 176, 176, 176, 176, 176
  .short 176, 176, 176, 176, 176, 176, 176, 176, 176, 176, 176, 176, 176, 176, 176, 176
  .short 176, 176, 176, 176, 176, 176, 176, 176, 176, 176, 176, 176, 176, 176, 176, 176
  .short 176, 176, 176, 176, 176, 176, 176, 176, 176, 176, 176, 176, 176, 176, 176, 176
  .short 176, 176, 176, 176, 176, 176, 176, 176, 176, 176, 176, 176, 176, 2968, 2960, 2776
  .short 2768, 2584, 2576, 2392, 2384, 2200, 2192, 2008, 2000, 1816, 1808, 1624, 1616, 1432, 1424, 1240
  .short 1232, 1048, 1040, 856, 848, 664, 656, 472, 464, 280, 272, 88, 80, 2952, 2944, 2760
  .short 2752, 2568, 2560, 2376, 2368, 2184, 2176, 1992, 1984, 1800, 1792, 1608, 1600, 1416, 1408, 1224
  .short 1216, 1032, 1024, 840, 832, 648, 640, 456, 448, 264, 256, 72, 64, 176, 176, 176
  .short 176, 176, 176, 176, 176, 176, 176, 176, 176, 176, 176, 176, 176, 176, 176, 176
  .short 176, 176, 176, 176, 176, 176, 176, 176, 176, 176, 176, 176, 176, 176, 176, 176
  .short 176, 176, 176, 176, 176, 176, 176, 176, 176, 176, 176, 176, 176, 176, 176, 176
  .short 176, 176, 176, 176, 176, 176, 176, 176, 176, 176, 176, 176, 176, 176, 176, 176
  .short 176, 176, 176, 176, 176, 176, 176, 176, 176, 176, 176, 176, 176, 176, 176, 176
  .short 176, 176, 176, 176, 176, 176, 176, 176, 176, 176, 176, 176, 176, 176, 176, 176
  .short 176, 176, 176, 176, 176, 176, 176, 176, 176, 176, 176, 176, 176, 176, 176, 176
  .short 176, 176, 176, 176, 176, 176, 176, 176, 176, 176, 176, 176, 176, 3048, 2964, 2780
  .short 2772, 2588, 2580, 2396, 2388, 2204, 2196, 2012, 2004, 1820, 1812, 1628, 1620, 1436, 1428, 1244
  .short 1236, 1052, 1044, 860, 852, 668, 660, 476, 468, 284, 276, 92, 84, 2956, 2948, 2764
  .short 2756, 2572, 2564, 2380, 2372, 2188, 2180, 1996, 1988, 1804, 1796, 1612, 1604, 1420, 1412, 1228
  .short 1220, 1036, 1028, 844, 836, 652, 644, 460, 452, 268, 260, 76, 68, 176, 176, 176
  .short 176, 176, 176, 176, 176, 176, 176, 176, 176, 176, 176, 176, 176, 176, 176, 176
  .short 176, 176, 176, 176, 176, 176, 176, 176, 176, 176, 176, 176, 176, 176, 176, 176
  .short 176, 176, 176, 176, 176, 176, 176, 176, 176, 176, 176, 176, 176, 176, 176, 176
  .short 176, 176, 176, 176, 176, 176, 176, 176, 176, 176, 176, 176, 176, 176, 176, 176
  .short 176, 176, 176, 176, 176, 176, 176, 176, 176, 176, 176, 176, 176, 176, 176, 176
  .short 176, 176, 176, 176, 176, 176, 176, 176, 176, 176, 176, 176, 176, 176, 176, 176
  .short 176, 176, 176, 176, 176, 176, 176, 176, 176, 176, 176, 176, 176, 176, 176, 176
  .short 176, 176, 176, 176, 176, 176, 176, 176, 176, 176, 176, 176, 176, 176, 176, 176
  .short 176, 176, 176, 176, 176, 176, 176, 176, 176, 176, 176, 176, 176, 176, 176, 176
  .short 176, 176, 176, 176, 176, 176, 176, 176, 176, 176, 176, 176, 176, 176, 176, 176
  .short 176, 176, 176, 176, 176, 176, 176, 176, 176, 176, 176, 176, 176, 176, 176, 176
  .short 176, 176, 176, 176, 176, 176, 176, 176, 176, 176, 176, 176, 176, 176, 176, 176
  .short 176, 176, 176, 176, 176, 176, 176, 176, 176, 176, 176, 176, 176, 176, 176, 176
  .short 176, 176, 176, 176, 176, 176, 176, 176, 176, 176, 176, 176, 176, 176, 176, 176
  .short 176, 176, 176, 176, 176, 176, 176, 176, 176, 176, 176, 176, 176, 176, 176, 176
  .short 176, 176, 176, 176, 176, 176, 176, 176, 176, 176, 176, 176, 176, 176, 176, 176
  .short 176, 176, 176, 176, 176, 176, 176, 176, 176, 176, 176, 176, 176, 176, 176, 176
  .short 176, 176, 176, 176, 176, 176, 176, 176, 176, 176, 176, 176, 176, 176, 176, 176
  .short 176, 176, 176, 176, 176, 176, 176, 176, 176, 176, 176, 176, 176, 176, 176, 176
  .short 176, 176, 176, 176, 176, 176, 176, 176, 176, 176, 176, 176, 176, 176, 176, 176
  .short 176, 176, 176, 176, 176, 176, 176, 176, 176, 176, 176, 176, 176, 176, 176, 176
  .short 176, 176, 176, 176, 176, 176, 176, 176, 176, 176, 176, 176, 176, 176, 176, 176
  .short 176, 176, 176, 176, 176, 176, 176, 176, 176, 176, 176, 176, 176, 176, 176, 176
  .short 176, 176, 176, 176, 176, 176, 176, 176, 176, 176, 176, 176, 176, 176, 176, 176
  .short 176, 176, 176, 176, 176, 176, 176, 176, 176, 176, 176, 176, 176, 176, 176, 176
  .short 176, 176, 176, 176, 176, 176, 176, 176, 176, 176, 176, 176, 176, 176, 176, 176
  .short 176, 176, 176, 176, 176, 176, 176, 176, 176, 176, 176, 176, 176, 176, 176, 176
  .short 176, 176, 176, 176, 176, 176, 176, 176, 176, 176, 176, 176, 176, 176, 176, 176
  .short 176, 176, 176, 176, 176, 176, 176, 176, 176, 176, 176, 176, 176, 176, 176, 176
  .short 176, 176, 176, 176, 176, 176, 176, 176, 176, 176, 176, 176, 176, 176, 176, 176
  .short 176, 176, 176, 176, 176, 176, 176, 176, 176, 176, 176, 176, 176, 176, 176, 176
  .short 176, 176, 176, 176, 176, 176, 176, 176, 176, 176, 176, 176, 176, 176, 176, 176
  .short 176, 176, 176, 176, 176, 176, 176, 176, 176, 176, 176, 176, 176, 176, 176, 176
  .short 176, 176, 176, 176, 176, 176, 176, 176, 176, 176, 176, 176, 176, 176, 176, 176
  .short 176, 176, 176, 176, 176, 176, 176, 176, 176, 176, 176, 176, 176, 176, 176, 176
  .short 176, 176, 176, 176, 176, 176, 176, 176, 176, 176, 176, 176, 176, 176, 176, 176
  .short 176, 176, 176, 176, 176, 176, 176, 176, 176, 176, 176, 176, 176, 176, 176, 176
  .short 176, 176, 176, 176, 176, 176, 176, 176, 176, 176, 176, 176, 176, 176, 176, 176
  .short 176, 176, 176, 176, 176, 176, 176, 176, 176, 176, 176, 176, 176, 176, 176, 176
  .short 176, 176, 176, 176, 176, 176, 176, 176, 176, 176, 176, 176, 176, 176, 176, 176
  .short 176, 176, 176, 176, 176, 176, 176, 176, 176, 176, 176, 176, 176, 176, 176, 176
  .short 176, 176, 176, 176, 176, 176, 176, 176, 176, 176, 176, 176, 176, 176, 176, 176
  .short 176, 176, 176, 176, 176, 176, 176, 176, 176, 176, 176, 176, 176, 176, 176, 176
  .short 176, 176, 176, 176, 176, 176, 176, 176, 176, 176, 176, 176, 176, 176, 176, 176
  .short 176, 176, 176, 176, 176, 176, 176, 176, 176, 176, 176, 176, 176, 176, 176, 176
  .short 176, 176, 176, 176, 176, 176, 176, 176, 176, 176, 176, 176, 176, 176, 176, 176
  .short 176, 176, 176, 176, 176, 176, 176, 176, 176, 176, 176, 176, 176, 176, 176, 176
  .short 176, 176, 176, 176, 176, 176, 176, 176, 176, 176, 176, 176, 176, 176, 176, 176
  .short 176, 176, 176, 176, 176, 176, 176, 176, 176, 176, 176, 176, 176, 176, 176, 176
  .short 176, 176, 176, 176, 176, 176, 176, 176, 176, 176, 176, 176, 176, 176, 176, 176
  .short 176, 176, 176, 176, 176, 176, 176, 176, 176, 176, 176, 176, 176, 176, 176, 176
  .short 176, 176, 176, 176, 176, 176, 176, 176, 176, 176, 176, 176, 176, 176, 176, 176
  .short 176, 176, 176, 176, 176, 176, 176, 176, 176, 176, 176, 176, 176, 176, 176, 176
  .short 176, 176, 176, 176, 176, 176, 176, 176, 176, 176, 176, 176, 176, 176, 176, 176
  .short 176, 176, 176, 176, 176, 176, 176, 176, 176, 176, 176, 176, 176, 176, 176, 176
  .short 176, 176, 176, 176, 176, 176, 176, 176, 176, 176, 176, 176, 176, 176, 176, 176
.size kimg_idx, 8192
.p2align 6
.amdhsa_kernel k3_kernel
  .amdhsa_next_free_vgpr 82
  .amdhsa_next_free_sgpr 64
  .amdhsa_accum_offset 84
  .amdhsa_group_segment_fixed_size 0
  .amdhsa_kernarg_size 120
  .amdhsa_user_sgpr_count 2
  .amdhsa_user_sgpr_kernarg_segment_ptr 1
  .amdhsa_system_sgpr_workgroup_id_x 1
.end_amdhsa_kernel
.p2align 6
.amdhsa_kernel gemm1_kernel
  .amdhsa_next_free_vgpr 168
  .amdhsa_next_free_sgpr 80
  .amdhsa_accum_offset 168
  .amdhsa_group_segment_fixed_size 0
  .amdhsa_kernarg_size 120
  .amdhsa_user_sgpr_count 2
  .amdhsa_user_sgpr_kernarg_segment_ptr 1
  .amdhsa_system_sgpr_workgroup_id_x 1
.end_amdhsa_kernel
.p2align 6
.amdhsa_kernel gemm2_kernel
  .amdhsa_next_free_vgpr 168
  .amdhsa_next_free_sgpr 80
  .amdhsa_accum_offset 168
  .amdhsa_group_segment_fixed_size 0
  .amdhsa_kernarg_size 120
  .amdhsa_user_sgpr_count 2
  .amdhsa_user_sgpr_kernarg_segment_ptr 1
  .amdhsa_system_sgpr_workgroup_id_x 1
.end_amdhsa_kernel
```
